```python
import torch

def _softmax(x, axis=-1):
    return torch.softmax(x, dim=axis)
def _gelu(x):
    return torch.nn.functional.gelu(x, approximate="tanh")
def _silu(x):
    return torch.nn.functional.silu(x)
def _sigmoid(x):
    return torch.sigmoid(x)
def _layernorm(x, axis=-1, eps=1e-5):
    m = x.mean(dim=axis, keepdim=True)
    v = x.var(dim=axis, keepdim=True, unbiased=False)
    return (x - m) / torch.sqrt(v + eps)
def _scatter_add(tgt, idx, src, axis=0):
    return tgt.clone().index_add_(axis, idx, src)
def _segment_sum(src, seg, n):
    out = torch.zeros((n,) + src.shape[1:], dtype=src.dtype)
    return out.index_add_(0, seg, src)
def _pad(x, pw):
    flat = tuple(v for pair in reversed(pw) for v in pair)
    return torch.nn.functional.pad(x, flat)

kernel_name = 'standalone__edge_featured_mpnn_gatedgcn__graph'

def setup_inputs():

    _w = (lambda a: (lambda t: t.to(torch.bfloat16) if t.is_floating_point() else t)(torch.as_tensor(a)))
    N, deg, D, De = 25000, 32, 64, max(4, 1)
    E = N * deg
    return {
        "x": _w((lambda *s: torch.randn(*s, dtype=torch.bfloat16) * 0.8)(N, D)),
        "e_attr": _w((lambda *s: torch.randn(*s, dtype=torch.bfloat16) * 0.8)(E, De)),
        "src": _w((lambda lo, hi, *s: torch.randint(lo, hi, s))(0, N, E).to(torch.int64)),
        "dst": _w((lambda lo, hi, *s: torch.randint(lo, hi, s))(0, N, E).to(torch.int64)),
        "w_a": _w((lambda *s: torch.randn(*s, dtype=torch.bfloat16) * 0.8)(D, D)),
        "w_b": _w((lambda *s: torch.randn(*s, dtype=torch.bfloat16) * 0.8)(D, D)),
        "w_c": _w((lambda *s: torch.randn(*s, dtype=torch.bfloat16) * 0.8)(De, D)),
        "w_u": _w((lambda *s: torch.randn(*s, dtype=torch.bfloat16) * 0.05)(D, D)),
        "w_v": _w((lambda *s: torch.randn(*s, dtype=torch.bfloat16) * 0.05)(D, D)),
    }

def reference(x, e_attr, src, dst, w_a, w_b, w_c, w_u, w_v):
    N, D = x.shape
    hv = x @ w_v
    g = x[dst] @ w_a + x[src] @ w_b + e_attr @ w_c
    eta = _sigmoid(g)
    denom = _segment_sum(eta, dst, N) + 1e-6
    eta_n = eta / denom[dst]
    agg = _segment_sum(eta_n * hv[src], dst, N)
    z = x @ w_u + agg
    relu_z = torch.where(z > 0, z, 0 * z)
    return x + relu_z
```

```asm
; @launch grid=(256,1,1) block=(512,1,1) lds=156672
.amdgcn_target "amdgcn-amd-amdhsa--gfx950"
.text
.globl standalone__edge_featured_mpnn_gatedgcn__graph_kernel
.p2align 8
.type standalone__edge_featured_mpnn_gatedgcn__graph_kernel,@function
standalone__edge_featured_mpnn_gatedgcn__graph_kernel:
    s_load_dwordx16 s[4:19], s[0:1], 0
    s_load_dwordx8 s[20:27], s[0:1], 64
    s_cmp_gt_u32 s2, 255
    s_cbranch_scc1 K_END
    s_setprio 3
    v_mov_b32 v60, v0
    v_lshrrev_b32 v144, 6, v0
    v_lshlrev_b32 v61, 4, v0
    v_readfirstlane_b32 s60, v144
    v_lshlrev_b32 v62, 5, v0
    v_and_b32 v0, 63, v0
    v_add_u32 v152, 8192, v61
    v_add_u32 v153, 16384, v62
    v_mov_b32 v64, 0
    v_mov_b32 v65, 0
    v_mov_b32 v66, 0
    v_mov_b32 v67, 0
    v_mov_b32 v63, 1
    ds_write_b128 v61, v[64:67] offset:52224
    s_min_u32 s3, s2, 249
    s_mul_i32 s92, s3, 12800
    s_lshl_b32 s93, s92, 1
    s_cmp_lt_u32 s2, 250
    s_cselect_b32 s94, 12800, 0
    s_cselect_b32 s95, 25600, 0
    s_cselect_b32 s96, 800, 0
    s_and_b32 s3, s2, 7
    s_lshl_b32 s3, s3, 5
    s_lshr_b32 s70, s2, 3
    s_add_u32 s70, s70, s3
    s_lshl_b32 s68, s60, 13
    s_add_u32 s67, s68, 82944
    s_add_u32 s68, s68, 1024
    s_lshl_b32 s61, s70, 3
    s_add_u32 s61, s61, s60
    s_mov_b32 s71, 0xc3569ae6
    s_lshl_b32 s3, s61, 13
    s_add_u32 s3, s3, 670
    s_mul_hi_u32 s62, s3, s71
    s_lshr_b32 s62, s62, 9
    s_add_u32 s3, s3, 8192
    s_mul_hi_u32 s63, s3, s71
    s_lshr_b32 s63, s63, 9
    s_waitcnt lgkmcnt(0)
    s_add_u32 s48, s10, s92
    s_addc_u32 s49, s11, 0
    s_and_b32 s49, s49, 0xffff
    s_mov_b32 s50, s94
    s_mov_b32 s51, 0x20000
    buffer_load_dwordx4 v[68:71], v61, s[48:51], 0 offen nt
    buffer_load_dwordx4 v[72:75], v152, s[48:51], 0 offen nt
    s_add_u32 s44, s26, 0xf00000
    s_addc_u32 s45, s27, 0
    s_and_b32 s45, s45, 0xffff
    s_mov_b32 s46, 0x8
    s_mov_b32 s47, 0x20000
    buffer_load_dwordx2 v[150:151], v64, s[44:47], 0 offen sc1
    s_add_u32 s40, s8, s92
    s_addc_u32 s41, s9, 0
    s_and_b32 s41, s41, 0xffff
    s_mov_b32 s42, s94
    s_mov_b32 s43, 0x20000
    s_add_u32 s36, s6, s93
    s_addc_u32 s37, s7, 0
    s_and_b32 s37, s37, 0xffff
    s_mov_b32 s38, s95
    s_mov_b32 s39, 0x20000
    buffer_load_dwordx4 v[76:79], v61, s[40:43], 0 offen nt
    buffer_load_dwordx4 v[80:83], v152, s[40:43], 0 offen nt
    v_cmp_gt_u32 vcc, s96, v60
    s_mov_b64 s[92:93], vcc
    v_add_u32 v144, 512, v60
    v_cmp_gt_u32 vcc, s96, v144
    s_mov_b64 s[94:95], vcc
    s_and_b32 s3, s60, 3
    s_cmp_eq_u32 s3, 1
    s_cselect_b32 s12, s18, s12
    s_cselect_b32 s13, s19, s13
    s_cmp_eq_u32 s3, 2
    s_cselect_b32 s12, s14, s12
    s_cselect_b32 s13, s15, s13
    s_cmp_eq_u32 s3, 3
    s_cselect_b32 s12, s20, s12
    s_cselect_b32 s13, s21, s13
    s_mov_b32 s48, s12
    s_and_b32 s49, s13, 0xffff
    s_mov_b32 s50, 0x2000
    s_mov_b32 s51, 0x20000
    s_mov_b32 s52, s16
    s_and_b32 s53, s17, 0xffff
    s_mov_b32 s54, 0x200
    s_mov_b32 s55, 0x20000
    s_mov_b32 s28, s4
    s_and_b32 s29, s5, 0xffff
    s_mov_b32 s30, 0x30d400
    s_mov_b32 s31, 0x20000
    v_lshrrev_b32 v16, 5, v0
    v_and_b32 v34, 31, v0
    v_lshlrev_b32 v34, 2, v34
    v_lshlrev_b32 v35, 4, v0
    v_lshrrev_b32 v144, 3, v0
    v_xor_b32 v145, v144, v0
    v_and_b32 v145, 7, v145
    v_lshlrev_b32 v145, 4, v145
    v_add_u32 v144, s62, v144
    v_sub_u32 v146, v144, v16
    v_add_u32 v146, 8, v146
    v_lshl_add_u32 v32, v144, 7, v145
    v_lshl_add_u32 v33, v146, 7, v145
    s_mul_i32 s3, s2, 51200
    s_add_u32 s56, s26, s3
    s_addc_u32 s57, s27, 0
    s_and_b32 s57, s57, 0xffff
    s_mov_b32 s58, 0xc800
    s_mov_b32 s59, 0x20000
    s_sub_u32 s32, s4, 3072
    s_subb_u32 s33, s5, 0
    s_and_b32 s33, s33, 0xffff
    s_or_b32 s33, s33, 0x800000
    s_mov_b32 s34, 0x61a8
    s_mov_b32 s35, 0x20000
    s_mov_b32 s80, 1024
    s_mov_b32 s81, 1024
    s_mov_b32 s82, 256
    s_mov_b32 s83, 1024
    s_mov_b32 s84, 3072
    s_mov_b32 s85, 2048
    s_mov_b32 s86, 1024
    s_mov_b32 s77, 800000
    s_mov_b32 s65, 0
    s_mov_b32 s69, 1
    s_mov_b32 s76, 2000000
    v_mov_b32 v144, 0x84210
    v_lshlrev_b32 v145, 1, v0
    v_bfe_u32 v144, v144, v145, 2
    v_mul_u32_u24 v144, 0x8001, v144
    v_and_b32 v144, 0x10001, v144
    v_mul_u32_u24 v144, 0x3f80, v144
    v_lshlrev_b32 v145, 2, v0
    s_mov_b64 exec, 0x3ff
    ds_write_b32 v145, v144 offset:0
    s_mov_b64 exec, -1
    v_mul_u32_u24 v146, 140, v0
    v_lshrrev_b32 v146, 7, v146
    v_lshlrev_b32 v146, 19, v146
    v_or_b32 v146, 0x80ffff, v146
    s_mov_b64 exec, 0x3fff
    ds_write_b32 v145, v146 offset:192
    s_mov_b64 exec, -1
    v_mul_u32_u24 v144, 11, v0
    v_lshrrev_b32 v144, 5, v144
    v_mad_i32_i24 v145, v144, -3, v0
    v_add_u32 v145, 1, v145
    v_lshl_add_u32 v144, v144, 1, 20
    v_lshlrev_b32 v146, v144, v145
    v_and_b32 v144, 3, v0
    v_add_u32 v144, 1, v144
    v_and_b32 v145, 12, v0
    v_lshl_add_u32 v145, v145, 1, 3
    v_lshlrev_b32 v147, v145, v144
    v_lshlrev_b32 v144, 3, v0
    v_xor_b32 v144, 0x80, v144
    s_mov_b64 exec, 0x10000
    v_mov_b32 v146, 0
    v_mov_b32 v147, 0
    s_mov_b64 exec, 0x1ffff
    v_or_b32 v146, 0x40000, v146
    ds_write_b64 v144, v[146:147] offset:256
    s_mov_b64 exec, -1
    s_mov_b32 s79, 800106
    v_and_b32 v11, 3, v0
    v_bfe_u32 v12, v0, 4, 1
    v_mul_u32_u24 v1, 0x5555, v12
    v_or_b32 v1, 0x8888, v1
    v_xor_b32 v13, v11, v16
    v_lshl_or_b32 v13, v12, 2, v13
    v_lshlrev_b32 v21, 4, v13
    v_mov_b32 v23, v21
    v_xor_b32 v25, 32, v21
    v_mov_b32 v27, v25
    v_bfe_u32 v13, v0, 3, 2
    v_xor_b32 v13, v13, v16
    v_lshlrev_b32 v8, 4, v13
    v_lshl_or_b32 v8, v11, 6, v8
    v_bfe_u32 v13, v0, 3, 1
    v_lshl_or_b32 v8, v13, 9, v8
    v_bfe_u32 v144, v0, 2, 1
    v_lshl_or_b32 v8, v144, 10, v8
    v_lshl_or_b32 v8, v12, 11, v8
    v_xor_b32 v9, 32, v8
    v_add_u32 v8, s67, v8
    v_add_u32 v9, s67, v9
    v_lshl_or_b32 v13, v144, 1, v13
    v_lshl_or_b32 v13, v13, 1, v12
    v_mad_u32_u24 v13, v13, 3, v11
    v_add_u32 v13, 9, v13
    v_and_b32 v13, 15, v13
    v_xor_b32 v144, v13, v16
    v_and_b32 v144, 7, v144
    v_lshlrev_b32 v144, 4, v144
    v_lshl_or_b32 v18, v13, 7, v144
    v_and_b32 v13, 15, v0
    v_xor_b32 v144, v13, v16
    v_and_b32 v144, 7, v144
    v_lshlrev_b32 v144, 4, v144
    v_lshl_or_b32 v19, v13, 7, v144
    v_lshlrev_b32 v144, 4, v16
    v_mov_b32 v145, 0x3f80
    v_lshlrev_b32 v29, v144, v145
    v_mov_b32 v30, v29
    v_mov_b32 v31, v29
    s_lshl_b32 s3, s60, 2
    v_mov_b32 v148, s3
    v_and_b32 v149, 7, v0
    v_lshlrev_b32 v149, 2, v149
    s_waitcnt lgkmcnt(0)
    s_barrier
    s_waitcnt vmcnt(3)
    s_mov_b64 exec, s[92:93]
    s_cbranch_execz P1_A
    v_mul_u32_u24 v68, 5368, v68
    v_lshrrev_b32 v116, 14, v68
    v_and_b32 v116, 0x1ffc, v116
    v_mul_u32_u24 v69, 5368, v69
    v_lshrrev_b32 v117, 14, v69
    v_and_b32 v117, 0x1ffc, v117
    v_mul_u32_u24 v70, 5368, v70
    v_lshrrev_b32 v118, 14, v70
    v_and_b32 v118, 0x1ffc, v118
    v_mul_u32_u24 v71, 5368, v71
    v_lshrrev_b32 v119, 14, v71
    v_and_b32 v119, 0x1ffc, v119
    ds_add_rtn_u32 v124, v116, v63 offset:52224
    ds_add_rtn_u32 v125, v117, v63 offset:52224
    ds_add_rtn_u32 v126, v118, v63 offset:52224
    ds_add_rtn_u32 v127, v119, v63 offset:52224
    s_mov_b64 exec, s[94:95]
    s_cbranch_execz P1_A
    v_mul_u32_u24 v72, 5368, v72
    v_lshrrev_b32 v120, 14, v72
    v_and_b32 v120, 0x1ffc, v120
    v_mul_u32_u24 v73, 5368, v73
    v_lshrrev_b32 v121, 14, v73
    v_and_b32 v121, 0x1ffc, v121
    v_mul_u32_u24 v74, 5368, v74
    v_lshrrev_b32 v122, 14, v74
    v_and_b32 v122, 0x1ffc, v122
    v_mul_u32_u24 v75, 5368, v75
    v_lshrrev_b32 v123, 14, v75
    v_and_b32 v123, 0x1ffc, v123
    ds_add_rtn_u32 v128, v120, v63 offset:52224
    ds_add_rtn_u32 v129, v121, v63 offset:52224
    ds_add_rtn_u32 v130, v122, v63 offset:52224
    ds_add_rtn_u32 v131, v123, v63 offset:52224
P1_A:
    s_mov_b64 exec, -1
    buffer_load_dwordx4 v[100:103], v153, s[36:39], 0 offen offset:0 nt
    buffer_load_dwordx4 v[108:111], v153, s[36:39], 0 offen offset:16 nt
    buffer_load_dwordx4 v[84:87], v62, s[36:39], 0 offen offset:0 nt
    buffer_load_dwordx4 v[92:95], v62, s[36:39], 0 offen offset:16 nt
    s_add_u32 s36, s26, 0xc80000
    s_addc_u32 s37, s27, 0
    s_and_b32 s37, s37, 0xffff
    s_mov_b32 s38, 0x280000
    s_mov_b32 s39, 0x20000
    s_mov_b32 s40, s26
    s_and_b32 s41, s27, 0xffff
    s_or_b32 s41, s41, 0x100000
    s_mov_b32 s42, 0xc3500
    s_mov_b32 s43, 0x20000
    v_and_b32 v68, 0xffff, v68
    v_mul_hi_u32_u24 v68, s79, v68
    v_lshlrev_b32 v68, 2, v68
    v_and_b32 v69, 0xffff, v69
    v_mul_hi_u32_u24 v69, s79, v69
    v_lshlrev_b32 v69, 2, v69
    v_and_b32 v70, 0xffff, v70
    v_mul_hi_u32_u24 v70, s79, v70
    v_lshlrev_b32 v70, 2, v70
    v_and_b32 v71, 0xffff, v71
    v_mul_hi_u32_u24 v71, s79, v71
    v_lshlrev_b32 v71, 2, v71
    v_and_b32 v72, 0xffff, v72
    v_mul_hi_u32_u24 v72, s79, v72
    v_lshlrev_b32 v72, 2, v72
    v_and_b32 v73, 0xffff, v73
    v_mul_hi_u32_u24 v73, s79, v73
    v_lshlrev_b32 v73, 2, v73
    v_and_b32 v74, 0xffff, v74
    v_mul_hi_u32_u24 v74, s79, v74
    v_lshlrev_b32 v74, 2, v74
    v_and_b32 v75, 0xffff, v75
    v_mul_hi_u32_u24 v75, s79, v75
    v_lshlrev_b32 v75, 2, v75
    ds_read_b32 v68, v68 offset:192
    ds_read_b32 v69, v69 offset:192
    ds_read_b32 v70, v70 offset:192
    ds_read_b32 v71, v71 offset:192
    ds_read_b32 v72, v72 offset:192
    ds_read_b32 v73, v73 offset:192
    ds_read_b32 v74, v74 offset:192
    ds_read_b32 v75, v75 offset:192
    s_waitcnt lgkmcnt(0)
    s_barrier
    ds_read_b128 v[132:135], v61 offset:52224
    s_waitcnt lgkmcnt(0)
    v_add_u32 v138, v132, v133
    v_add_u32 v139, v138, v134
    v_add_u32 v144, v139, v135
    v_mov_b32 v145, v144
    v_max3_u32 v146, v132, v133, v134
    v_max_u32 v146, v146, v135
    v_add_u32_dpp v145, v145, v145 row_shr:1 row_mask:0xf bank_mask:0xf
    v_cmp_lt_u32 vcc, 14, v146
    v_min_u32 v160, 15, v132
    v_add_u32_dpp v145, v145, v145 row_shr:2 row_mask:0xf bank_mask:0xf
    v_min_u32 v161, 15, v133
    v_min_u32 v162, 15, v134
    v_add_u32_dpp v145, v145, v145 row_shr:4 row_mask:0xf bank_mask:0xf
    v_min_u32 v163, 15, v135
    v_lshl_or_b32 v160, v161, 4, v160
    v_add_u32_dpp v145, v145, v145 row_shr:8 row_mask:0xf bank_mask:0xf
    v_lshl_or_b32 v162, v163, 4, v162
    v_lshl_or_b32 v160, v162, 8, v160
    v_add_u32_dpp v145, v145, v145 row_bcast:15 row_mask:0xa bank_mask:0xf
    v_lshrrev_b32 v163, 2, v61
    v_mov_b32_dpp v161, v160 quad_perm:[1,1,3,3] row_mask:0xf bank_mask:0xf
    v_add_u32_dpp v145, v145, v145 row_bcast:31 row_mask:0xc bank_mask:0xf
    s_mov_b32 exec_lo, 0
    s_mov_b32 exec_hi, 0x80000000
    ds_write_b32 v148, v145 offset:128
    s_mov_b64 exec, -1
    s_waitcnt vmcnt(6)
    v_readfirstlane_b32 s74, v150
    v_readfirstlane_b32 s88, v151
    s_nop 0
    s_nop 0
    s_mul_i32 s74, s74, 1664525
    s_add_u32 s74, s74, 1013904223
    s_mul_i32 s88, s88, 22695477
    s_add_u32 s88, s88, 0x9e3779b9
    s_and_b32 s75, s88, 0xffff0000
    s_lshr_b32 s87, s88, 24
    s_and_b32 s78, s88, 0xff000000
    s_mov_b32 s79, 0xffff
    s_waitcnt lgkmcnt(0)
    s_barrier
    ds_read_b32 v146, v149 offset:128
    v_lshl_or_b32 v156, v161, 16, v160
    v_mov_b32 v159, s74
    s_nop 0
    v_mov_b32_dpp v157, v156 quad_perm:[2,2,2,2] row_mask:0xf bank_mask:0xf
    s_waitcnt lgkmcnt(0)
    v_mov_b32 v147, v146
    s_nop 0
    s_nop 0
    v_add_u32_dpp v147, v147, v147 row_shr:1 row_mask:0xf bank_mask:0xf
    s_nop 0
    s_nop 0
    v_add_u32_dpp v147, v147, v147 row_shr:2 row_mask:0xf bank_mask:0xf
    s_nop 0
    s_nop 0
    v_add_u32_dpp v147, v147, v147 row_shr:4 row_mask:0xf bank_mask:0xf
    v_sub_u32 v147, v147, v146
    s_nop 0
    v_readlane_b32 s3, v147, s60
    s_lshl_b32 s91, s2, 11
    s_nop 0
    v_add_u32 v145, s3, v145
    v_sub_u32 v136, v145, v144
    v_add_u32 v137, v136, v132
    v_add_u32 v138, v136, v138
    v_add_u32 v139, v136, v139
    v_mov_b32_dpp v158, v136 quad_perm:[2,2,2,2] row_mask:0xf bank_mask:0xf
    ds_write_b128 v61, v[136:139] offset:52224
    v_lshl_or_b32 v158, v158, 12, v136
    v_or_b32 v158, s78, v158
    s_cbranch_vccnz PUB_X
PUB_C:
    s_mov_b32 exec_lo, 0x11111111
    s_mov_b32 exec_hi, 0x11111111
    buffer_store_dwordx4 v[156:159], v163, s[36:39], s91 offen sc1
    s_mov_b64 exec, -1
    s_waitcnt lgkmcnt(0)
    s_barrier
    ds_read_b32 v116, v116 offset:52224
    ds_read_b32 v117, v117 offset:52224
    ds_read_b32 v118, v118 offset:52224
    ds_read_b32 v119, v119 offset:52224
    ds_read_b32 v120, v120 offset:52224
    ds_read_b32 v121, v121 offset:52224
    ds_read_b32 v122, v122 offset:52224
    ds_read_b32 v123, v123 offset:52224
    s_waitcnt vmcnt(1)
    s_mov_b64 exec, s[92:93]
    s_cbranch_execz P1_B
    v_mov_b32 v88, v86
    v_mov_b32 v89, v87
    v_mov_b32 v96, v94
    v_mov_b32 v97, v95
    v_bitop3_b32 v86, v68, v76, s78 bitop3:0x96
    v_mov_b32 v87, s74
    v_bitop3_b32 v90, v69, v77, s78 bitop3:0x96
    v_mov_b32 v91, s74
    v_bitop3_b32 v94, v70, v78, s78 bitop3:0x96
    v_mov_b32 v95, s74
    v_bitop3_b32 v98, v71, v79, s78 bitop3:0x96
    v_mov_b32 v99, s74
    s_waitcnt lgkmcnt(4)
    v_add_lshl_u32 v116, v124, v116, 4
    v_add_lshl_u32 v117, v125, v117, 4
    v_add_lshl_u32 v118, v126, v118, 4
    v_add_lshl_u32 v119, v127, v119, 4
    ds_write_b128 v116, v[84:87] offset:1024
    ds_write_b128 v117, v[88:91] offset:1024
    ds_write_b128 v118, v[92:95] offset:1024
    ds_write_b128 v119, v[96:99] offset:1024
    s_mov_b64 exec, s[94:95]
    s_cbranch_execz P1_B
    v_mov_b32 v104, v102
    v_mov_b32 v105, v103
    v_mov_b32 v112, v110
    v_mov_b32 v113, v111
    v_bitop3_b32 v102, v72, v80, s78 bitop3:0x96
    v_mov_b32 v103, s74
    v_bitop3_b32 v106, v73, v81, s78 bitop3:0x96
    v_mov_b32 v107, s74
    v_bitop3_b32 v110, v74, v82, s78 bitop3:0x96
    v_mov_b32 v111, s74
    v_bitop3_b32 v114, v75, v83, s78 bitop3:0x96
    v_mov_b32 v115, s74
    s_waitcnt lgkmcnt(4)
    v_add_lshl_u32 v120, v128, v120, 4
    v_add_lshl_u32 v121, v129, v121, 4
    v_add_lshl_u32 v122, v130, v122, 4
    v_add_lshl_u32 v123, v131, v123, 4
    ds_write_b128 v120, v[100:103] offset:1024
    ds_write_b128 v121, v[104:107] offset:1024
    ds_write_b128 v122, v[108:111] offset:1024
    ds_write_b128 v123, v[112:115] offset:1024
P1_B:
    s_mov_b64 exec, -1
    s_cmp_lt_u32 s60, 4
    s_cbranch_scc1 LATE_B
    s_and_b32 s93, s60, 3
    s_lshl_b32 s93, s93, 14
    s_add_u32 m0, s93, 82944
    s_mov_b32 s3, 4096
    buffer_load_dwordx4 v35, s[48:51], 0 offen offset:0  lds
    buffer_load_dwordx4 v35, s[48:51], 0 offen offset:1024  lds
    buffer_load_dwordx4 v35, s[48:51], 0 offen offset:2048  lds
    buffer_load_dwordx4 v35, s[48:51], 0 offen offset:3072  lds
    s_add_u32 m0, s93, 91136
    s_nop 0
    buffer_load_dwordx4 v35, s[48:51], s3 offen offset:0  lds
    buffer_load_dwordx4 v35, s[48:51], s3 offen offset:1024  lds
    buffer_load_dwordx4 v35, s[48:51], s3 offen offset:2048  lds
    buffer_load_dwordx4 v35, s[48:51], s3 offen offset:3072  lds
LATE_B:
    s_mov_b32 exec_hi, 0
    buffer_load_dword v52, v34, s[52:55], 0 offen offset:0
    buffer_load_dword v53, v34, s[52:55], 0 offen offset:128
    buffer_load_dword v54, v34, s[52:55], 0 offen offset:256
    buffer_load_dword v55, v34, s[52:55], 0 offen offset:384
    s_mov_b64 exec, -1
    s_lshl_b32 s3, s60, 11
    s_add_u32 m0, s3, 66560
    s_nop 0
    buffer_load_dwordx4 v32, s[28:31], 0 offen  lds
    s_add_u32 m0, s3, 67584
    s_nop 0
    buffer_load_dwordx4 v33, s[28:31], 0 offen  lds
    v_and_b32 v146, 255, v60
    v_lshlrev_b32 v144, 11, v146
    s_lshr_b32 s97, s70, 1
    s_lshl_b32 s97, s97, 4
    v_lshlrev_b32 v145, 2, v146
    v_add_u32 v145, 148480, v145
    v_add_u32 v13, 87040, v35
    s_mov_b32 s92, 0xbfb8aa3b
    v_mov_b32 v156, 0
    v_mov_b32 v157, 0
    v_mov_b32 v158, 0
    v_mov_b32 v159, 0
    v_lshl_add_u32 v168, v0, 5, s68
    v_mul_u32_u24 v169, 12800, v0
    v_subrev_u32 v169, s65, v169
    v_lshl_add_u32 v171, v0, 3, s65
    v_mov_b32 v4, 512
    v_mov_b32 v170, 0
    v_lshl_add_u32 v6, v0, 2, s68
    s_lshl_b32 s3, s60, 2
    v_mov_b32 v5, s3
    s_lshl_b32 s3, s60, 10
    s_add_u32 s3, s3, 148480
    v_add_u32 v14, s3, v35
    s_waitcnt lgkmcnt(0)
    s_barrier
    s_cmp_gt_u32 s60, 3
    s_cbranch_scc1 P1_D
    s_cmp_ge_u32 s2, 250
    s_cbranch_scc1 P1_N
    ds_read_b128 v[68:71], v61 offset:1024
    ds_read_b128 v[72:75], v61 offset:5120
    ds_read_b128 v[76:79], v61 offset:9216
    ds_read_b128 v[80:83], v61 offset:13312
    ds_read_b128 v[84:87], v61 offset:17408
    ds_read_b128 v[88:91], v61 offset:21504
    ds_read_b128 v[92:95], v61 offset:25600
    ds_read_b128 v[96:99], v61 offset:29696
    ds_read_b128 v[100:103], v61 offset:33792
    ds_read_b128 v[104:107], v61 offset:37888
    ds_read_b128 v[108:111], v61 offset:41984
    ds_read_b128 v[112:115], v61 offset:46080
    ds_read_b128 v[116:119], v61 offset:50176
    v_add_u32 v62, 49152, v61
    s_mov_b32 s3, 0
    s_waitcnt lgkmcnt(12)
    buffer_store_dwordx4 v[68:71], v61, s[56:59], s3 offen sc1
    s_mov_b32 s3, 4096
    s_waitcnt lgkmcnt(11)
    buffer_store_dwordx4 v[72:75], v61, s[56:59], s3 offen sc1
    s_mov_b32 s3, 8192
    s_waitcnt lgkmcnt(10)
    buffer_store_dwordx4 v[76:79], v61, s[56:59], s3 offen sc1
    s_mov_b32 s3, 12288
    s_waitcnt lgkmcnt(9)
    buffer_store_dwordx4 v[80:83], v61, s[56:59], s3 offen sc1
    s_mov_b32 s3, 16384
    s_waitcnt lgkmcnt(8)
    buffer_store_dwordx4 v[84:87], v61, s[56:59], s3 offen sc1
    s_mov_b32 s3, 20480
    s_waitcnt lgkmcnt(7)
    buffer_store_dwordx4 v[88:91], v61, s[56:59], s3 offen sc1
    s_mov_b32 s3, 24576
    s_waitcnt lgkmcnt(6)
    buffer_store_dwordx4 v[92:95], v61, s[56:59], s3 offen sc1
    s_mov_b32 s3, 28672
    s_waitcnt lgkmcnt(5)
    buffer_store_dwordx4 v[96:99], v61, s[56:59], s3 offen sc1
    s_mov_b32 s3, 32768
    s_waitcnt lgkmcnt(4)
    buffer_store_dwordx4 v[100:103], v61, s[56:59], s3 offen sc1
    s_mov_b32 s3, 36864
    s_waitcnt lgkmcnt(3)
    buffer_store_dwordx4 v[104:107], v61, s[56:59], s3 offen sc1
    s_mov_b32 s3, 40960
    s_waitcnt lgkmcnt(2)
    buffer_store_dwordx4 v[108:111], v61, s[56:59], s3 offen sc1
    s_mov_b32 s3, 45056
    s_waitcnt lgkmcnt(1)
    buffer_store_dwordx4 v[112:115], v61, s[56:59], s3 offen sc1
    s_waitcnt lgkmcnt(0)
    buffer_store_dwordx4 v[116:119], v62, s[56:59], 0 offen sc1
    s_waitcnt vmcnt(13)
    s_branch POLL_DONE
P1_N:
    s_waitcnt vmcnt(0)
    s_branch POLL_DONE
P1_D:
    buffer_load_dwordx4 v[140:143], v144, s[36:39], s97 offen sc1
    v_lshl_add_u32 v146, v16, 10, v34
    s_add_u32 s3, s93, 82944
    v_add_u32 v146, s3, v146
    s_waitcnt vmcnt(7)
    ds_read_b32 v68, v146 offset:0
    ds_read_b32 v69, v146 offset:128
    ds_read_b32 v70, v146 offset:256
    ds_read_b32 v71, v146 offset:384
    ds_read_b32 v72, v146 offset:512
    ds_read_b32 v73, v146 offset:640
    ds_read_b32 v74, v146 offset:768
    ds_read_b32 v75, v146 offset:896
    ds_read_b32 v76, v146 offset:2048
    ds_read_b32 v77, v146 offset:2176
    ds_read_b32 v78, v146 offset:2304
    ds_read_b32 v79, v146 offset:2432
    ds_read_b32 v80, v146 offset:2560
    ds_read_b32 v81, v146 offset:2688
    ds_read_b32 v82, v146 offset:2816
    ds_read_b32 v83, v146 offset:2944
    ds_read_b32 v84, v146 offset:8192
    ds_read_b32 v85, v146 offset:8320
    ds_read_b32 v86, v146 offset:8448
    ds_read_b32 v87, v146 offset:8576
    ds_read_b32 v88, v146 offset:8704
    ds_read_b32 v89, v146 offset:8832
    ds_read_b32 v90, v146 offset:8960
    ds_read_b32 v91, v146 offset:9088
    ds_read_b32 v92, v146 offset:10240
    ds_read_b32 v93, v146 offset:10368
    ds_read_b32 v94, v146 offset:10496
    ds_read_b32 v95, v146 offset:10624
    ds_read_b32 v96, v146 offset:10752
    ds_read_b32 v97, v146 offset:10880
    ds_read_b32 v98, v146 offset:11008
    ds_read_b32 v99, v146 offset:11136
    s_bitcmp0_b32 s60, 0
    s_cselect_b32 s3, s92, 1.0
    v_add_u32 v146, s93, v13
    s_waitcnt lgkmcnt(15)
    s_nop 0
    v_lshlrev_b32 v172, 16, v68
    v_and_b32 v188, 0xffff0000, v68
    v_lshlrev_b32 v173, 16, v69
    v_and_b32 v189, 0xffff0000, v69
    v_lshlrev_b32 v174, 16, v70
    v_and_b32 v190, 0xffff0000, v70
    v_lshlrev_b32 v175, 16, v71
    v_and_b32 v191, 0xffff0000, v71
    v_lshlrev_b32 v176, 16, v72
    v_and_b32 v192, 0xffff0000, v72
    v_lshlrev_b32 v177, 16, v73
    v_and_b32 v193, 0xffff0000, v73
    v_lshlrev_b32 v178, 16, v74
    v_and_b32 v194, 0xffff0000, v74
    v_lshlrev_b32 v179, 16, v75
    v_and_b32 v195, 0xffff0000, v75
    v_lshlrev_b32 v180, 16, v76
    v_and_b32 v196, 0xffff0000, v76
    v_lshlrev_b32 v181, 16, v77
    v_and_b32 v197, 0xffff0000, v77
    v_lshlrev_b32 v182, 16, v78
    v_and_b32 v198, 0xffff0000, v78
    v_lshlrev_b32 v183, 16, v79
    v_and_b32 v199, 0xffff0000, v79
    v_lshlrev_b32 v184, 16, v80
    v_and_b32 v200, 0xffff0000, v80
    v_lshlrev_b32 v185, 16, v81
    v_and_b32 v201, 0xffff0000, v81
    v_lshlrev_b32 v186, 16, v82
    v_and_b32 v202, 0xffff0000, v82
    v_lshlrev_b32 v187, 16, v83
    v_and_b32 v203, 0xffff0000, v83
    v_pk_mul_f32 v[172:173], v[172:173], s[2:3] op_sel:[0,1] op_sel_hi:[1,1]
    v_pk_mul_f32 v[174:175], v[174:175], s[2:3] op_sel:[0,1] op_sel_hi:[1,1]
    v_pk_mul_f32 v[176:177], v[176:177], s[2:3] op_sel:[0,1] op_sel_hi:[1,1]
    v_pk_mul_f32 v[178:179], v[178:179], s[2:3] op_sel:[0,1] op_sel_hi:[1,1]
    v_pk_mul_f32 v[180:181], v[180:181], s[2:3] op_sel:[0,1] op_sel_hi:[1,1]
    v_pk_mul_f32 v[182:183], v[182:183], s[2:3] op_sel:[0,1] op_sel_hi:[1,1]
    v_pk_mul_f32 v[184:185], v[184:185], s[2:3] op_sel:[0,1] op_sel_hi:[1,1]
    v_pk_mul_f32 v[186:187], v[186:187], s[2:3] op_sel:[0,1] op_sel_hi:[1,1]
    v_pk_mul_f32 v[188:189], v[188:189], s[2:3] op_sel:[0,1] op_sel_hi:[1,1]
    v_pk_mul_f32 v[190:191], v[190:191], s[2:3] op_sel:[0,1] op_sel_hi:[1,1]
    v_pk_mul_f32 v[192:193], v[192:193], s[2:3] op_sel:[0,1] op_sel_hi:[1,1]
    v_pk_mul_f32 v[194:195], v[194:195], s[2:3] op_sel:[0,1] op_sel_hi:[1,1]
    v_pk_mul_f32 v[196:197], v[196:197], s[2:3] op_sel:[0,1] op_sel_hi:[1,1]
    v_pk_mul_f32 v[198:199], v[198:199], s[2:3] op_sel:[0,1] op_sel_hi:[1,1]
    v_pk_mul_f32 v[200:201], v[200:201], s[2:3] op_sel:[0,1] op_sel_hi:[1,1]
    v_pk_mul_f32 v[202:203], v[202:203], s[2:3] op_sel:[0,1] op_sel_hi:[1,1]
    v_cvt_pk_bf16_f32 v204, v172, v173
    v_cvt_pk_bf16_f32 v205, v174, v175
    v_cvt_pk_bf16_f32 v206, v176, v177
    v_cvt_pk_bf16_f32 v207, v178, v179
    v_cvt_pk_bf16_f32 v208, v180, v181
    v_cvt_pk_bf16_f32 v209, v182, v183
    v_cvt_pk_bf16_f32 v210, v184, v185
    v_cvt_pk_bf16_f32 v211, v186, v187
    v_cvt_pk_bf16_f32 v212, v188, v189
    v_cvt_pk_bf16_f32 v213, v190, v191
    v_cvt_pk_bf16_f32 v214, v192, v193
    v_cvt_pk_bf16_f32 v215, v194, v195
    v_cvt_pk_bf16_f32 v216, v196, v197
    v_cvt_pk_bf16_f32 v217, v198, v199
    v_cvt_pk_bf16_f32 v218, v200, v201
    v_cvt_pk_bf16_f32 v219, v202, v203
    ds_write_b128 v146, v[204:207] offset:0
    ds_write_b128 v146, v[208:211] offset:1024
    ds_write_b128 v146, v[212:215] offset:8192
    ds_write_b128 v146, v[216:219] offset:9216
    s_waitcnt lgkmcnt(4)
    v_lshlrev_b32 v172, 16, v84
    v_and_b32 v188, 0xffff0000, v84
    v_lshlrev_b32 v173, 16, v85
    v_and_b32 v189, 0xffff0000, v85
    v_lshlrev_b32 v174, 16, v86
    v_and_b32 v190, 0xffff0000, v86
    v_lshlrev_b32 v175, 16, v87
    v_and_b32 v191, 0xffff0000, v87
    v_lshlrev_b32 v176, 16, v88
    v_and_b32 v192, 0xffff0000, v88
    v_lshlrev_b32 v177, 16, v89
    v_and_b32 v193, 0xffff0000, v89
    v_lshlrev_b32 v178, 16, v90
    v_and_b32 v194, 0xffff0000, v90
    v_lshlrev_b32 v179, 16, v91
    v_and_b32 v195, 0xffff0000, v91
    v_lshlrev_b32 v180, 16, v92
    v_and_b32 v196, 0xffff0000, v92
    v_lshlrev_b32 v181, 16, v93
    v_and_b32 v197, 0xffff0000, v93
    v_lshlrev_b32 v182, 16, v94
    v_and_b32 v198, 0xffff0000, v94
    v_lshlrev_b32 v183, 16, v95
    v_and_b32 v199, 0xffff0000, v95
    v_lshlrev_b32 v184, 16, v96
    v_and_b32 v200, 0xffff0000, v96
    v_lshlrev_b32 v185, 16, v97
    v_and_b32 v201, 0xffff0000, v97
    v_lshlrev_b32 v186, 16, v98
    v_and_b32 v202, 0xffff0000, v98
    v_lshlrev_b32 v187, 16, v99
    v_and_b32 v203, 0xffff0000, v99
    v_pk_mul_f32 v[172:173], v[172:173], s[2:3] op_sel:[0,1] op_sel_hi:[1,1]
    v_pk_mul_f32 v[174:175], v[174:175], s[2:3] op_sel:[0,1] op_sel_hi:[1,1]
    v_pk_mul_f32 v[176:177], v[176:177], s[2:3] op_sel:[0,1] op_sel_hi:[1,1]
    v_pk_mul_f32 v[178:179], v[178:179], s[2:3] op_sel:[0,1] op_sel_hi:[1,1]
    v_pk_mul_f32 v[180:181], v[180:181], s[2:3] op_sel:[0,1] op_sel_hi:[1,1]
    v_pk_mul_f32 v[182:183], v[182:183], s[2:3] op_sel:[0,1] op_sel_hi:[1,1]
    v_pk_mul_f32 v[184:185], v[184:185], s[2:3] op_sel:[0,1] op_sel_hi:[1,1]
    v_pk_mul_f32 v[186:187], v[186:187], s[2:3] op_sel:[0,1] op_sel_hi:[1,1]
    v_pk_mul_f32 v[188:189], v[188:189], s[2:3] op_sel:[0,1] op_sel_hi:[1,1]
    v_pk_mul_f32 v[190:191], v[190:191], s[2:3] op_sel:[0,1] op_sel_hi:[1,1]
    v_pk_mul_f32 v[192:193], v[192:193], s[2:3] op_sel:[0,1] op_sel_hi:[1,1]
    v_pk_mul_f32 v[194:195], v[194:195], s[2:3] op_sel:[0,1] op_sel_hi:[1,1]
    v_pk_mul_f32 v[196:197], v[196:197], s[2:3] op_sel:[0,1] op_sel_hi:[1,1]
    v_pk_mul_f32 v[198:199], v[198:199], s[2:3] op_sel:[0,1] op_sel_hi:[1,1]
    v_pk_mul_f32 v[200:201], v[200:201], s[2:3] op_sel:[0,1] op_sel_hi:[1,1]
    v_pk_mul_f32 v[202:203], v[202:203], s[2:3] op_sel:[0,1] op_sel_hi:[1,1]
    v_cvt_pk_bf16_f32 v220, v172, v173
    v_cvt_pk_bf16_f32 v221, v174, v175
    v_cvt_pk_bf16_f32 v222, v176, v177
    v_cvt_pk_bf16_f32 v223, v178, v179
    v_cvt_pk_bf16_f32 v224, v180, v181
    v_cvt_pk_bf16_f32 v225, v182, v183
    v_cvt_pk_bf16_f32 v226, v184, v185
    v_cvt_pk_bf16_f32 v227, v186, v187
    v_cvt_pk_bf16_f32 v228, v188, v189
    v_cvt_pk_bf16_f32 v229, v190, v191
    v_cvt_pk_bf16_f32 v230, v192, v193
    v_cvt_pk_bf16_f32 v231, v194, v195
    v_cvt_pk_bf16_f32 v232, v196, v197
    v_cvt_pk_bf16_f32 v233, v198, v199
    v_cvt_pk_bf16_f32 v234, v200, v201
    v_cvt_pk_bf16_f32 v235, v202, v203
    ds_write_b128 v146, v[220:223] offset:2048
    ds_write_b128 v146, v[224:227] offset:3072
    ds_write_b128 v146, v[228:231] offset:10240
    ds_write_b128 v146, v[232:235] offset:11264
POLL:
    s_waitcnt vmcnt(0)
    v_cmp_ne_u32 vcc, s74, v143
    v_cmp_ne_u32_sdwa s[6:7], v142, s87 src0_sel:BYTE_3 src1_sel:DWORD
    s_or_b64 vcc, vcc, s[6:7]
    s_cbranch_scc0 POLL_OK
    s_mov_b64 exec, vcc
    buffer_load_dwordx4 v[140:143], v144, s[36:39], s97 offen sc1
    s_sub_u32 s76, s76, 1
    s_cbranch_scc0 POLL
    s_endpgm
POLL_OK:
    s_mov_b64 exec, -1
    s_bitcmp1_b32 s70, 0
    s_cselect_b32 s3, 12, 0
    s_cbranch_scc0 POLL_E
    v_mov_b32 v140, v141
POLL_E:
    v_bfe_u32 v68, v142, s3, 12
    v_lshrrev_b32 v11, 1, v140
    v_and_b32 v11, v11, v140
    v_lshrrev_b32 v12, 2, v11
    v_and_b32 v11, v11, v12
    v_and_b32 v11, 0x11111111, v11
    v_cmp_ne_u32 vcc, 0, v11
    v_bfe_u32 v12, v140, 0, 4
    v_add_u32 v69, v12, v68
    v_bfe_u32 v12, v140, 4, 4
    v_add_u32 v70, v12, v69
    v_bfe_u32 v12, v140, 8, 4
    v_add_u32 v71, v12, v70
    v_bfe_u32 v12, v140, 12, 4
    v_add_u32 v72, v12, v71
    v_bfe_u32 v12, v140, 16, 4
    v_add_u32 v73, v12, v72
    v_bfe_u32 v12, v140, 20, 4
    v_add_u32 v74, v12, v73
    v_bfe_u32 v12, v140, 24, 4
    v_add_u32 v75, v12, v74
    v_bfe_u32 v12, v140, 28, 4
    v_add_u32 v76, v12, v75
    v_lshl_or_b32 v68, v69, 16, v68
    v_lshl_or_b32 v69, v70, 16, v69
    v_lshl_or_b32 v70, v71, 16, v70
    v_lshl_or_b32 v71, v72, 16, v71
    v_lshl_or_b32 v72, v73, 16, v72
    v_lshl_or_b32 v73, v74, 16, v73
    v_lshl_or_b32 v74, v75, 16, v74
    v_lshl_or_b32 v75, v76, 16, v75
    s_cbranch_vccnz ESCAPE
ESC_DONE:
    ds_write_b32 v145, v68 offset:0
    ds_write_b32 v145, v69 offset:1024
    ds_write_b32 v145, v70 offset:2048
    ds_write_b32 v145, v71 offset:3072
    ds_write_b32 v145, v72 offset:4096
    ds_write_b32 v145, v73 offset:5120
    ds_write_b32 v145, v74 offset:6144
    ds_write_b32 v145, v75 offset:7168
POLL_DONE:
    s_waitcnt lgkmcnt(0)
    s_barrier
    ds_read_b128 v[140:143], v14
    ds_write_b128 v168, v[156:159] offset:6128
    ds_write_b128 v168, v[156:159] offset:6144
    ds_read_b128 v[172:175], v13 offset:32768
    ds_read_b128 v[176:179], v13 offset:33792
    ds_read_b128 v[180:183], v13 offset:34816
    ds_read_b128 v[184:187], v13 offset:35840
    ds_read_b128 v[188:191], v13 offset:40960
    ds_read_b128 v[192:195], v13 offset:41984
    ds_read_b128 v[196:199], v13 offset:43008
    ds_read_b128 v[200:203], v13 offset:44032
    s_or_b32 s3, s2, s60
    s_cbranch_scc1 NOBUMP
    v_mov_b32 v32, s74
    v_mov_b32 v33, s88
    v_lshlrev_b32 v12, 3, v0
    buffer_store_dwordx2 v[32:33], v12, s[44:47], 0 offen sc0 sc1
NOBUMP:
    s_waitcnt lgkmcnt(10)
EXPAND:
    v_sub_u32_sdwa v161, v140, v140 dst_sel:DWORD dst_unused:UNUSED_PAD src0_sel:WORD_1 src1_sel:WORD_0
    v_sub_u32_sdwa v162, v141, v141 dst_sel:DWORD dst_unused:UNUSED_PAD src0_sel:WORD_1 src1_sel:WORD_0
    v_sub_u32_sdwa v163, v142, v142 dst_sel:DWORD dst_unused:UNUSED_PAD src0_sel:WORD_1 src1_sel:WORD_0
    v_sub_u32_sdwa v3, v143, v143 dst_sel:DWORD dst_unused:UNUSED_PAD src0_sel:WORD_1 src1_sel:WORD_0
    v_add_u32 v162, v161, v162
    v_add_u32 v163, v162, v163
    v_add_u32 v3, v163, v3
    v_add_u32 v2, s65, v3
    v_add_u32_sdwa v164, v140, v169 dst_sel:DWORD dst_unused:UNUSED_PAD src0_sel:WORD_0 src1_sel:DWORD
    v_add_u32_dpp v3, v3, v3 row_shr:1 row_mask:0xf bank_mask:0xf
    v_add_u32_sdwa v165, v141, v169 dst_sel:DWORD dst_unused:UNUSED_PAD src0_sel:WORD_0 src1_sel:DWORD
    v_add_u32_sdwa v166, v142, v169 dst_sel:DWORD dst_unused:UNUSED_PAD src0_sel:WORD_0 src1_sel:DWORD
    v_add_u32_dpp v3, v3, v3 row_shr:2 row_mask:0xf bank_mask:0xf
    v_add_u32_sdwa v167, v143, v169 dst_sel:DWORD dst_unused:UNUSED_PAD src0_sel:WORD_0 src1_sel:DWORD
    v_add_u32 v165, 3200, v165
    v_add_u32_dpp v3, v3, v3 row_shr:4 row_mask:0xf bank_mask:0xf
    v_add_u32 v166, 6400, v166
    v_add_u32 v167, 9600, v167
    v_add_u32_dpp v3, v3, v3 row_shr:8 row_mask:0xf bank_mask:0xf
    v_sub_u32 v161, v161, v2
    v_sub_u32 v162, v162, v2
    v_add_u32_dpp v3, v3, v3 row_bcast:15 row_mask:0xa bank_mask:0xf
    v_sub_u32 v163, v163, v2
    s_nop 0
    v_add_u32_dpp v3, v3, v3 row_bcast:31 row_mask:0xc bank_mask:0xf
    v_sub_u32 v160, v3, v2
    v_readlane_b32 s64, v3, 63
    v_add_u32 v161, v3, v161
    v_add_u32 v162, v3, v162
    v_add_u32 v163, v3, v163
    v_sub_u32 v164, v164, v160
    v_med3_i32 v160, v160, 0, v4
    v_lshl_add_u32 v160, v160, 2, s68
    v_sub_u32 v165, v165, v161
    v_med3_i32 v161, v161, 0, v4
    v_lshl_add_u32 v161, v161, 2, s68
    v_sub_u32 v166, v166, v162
    v_med3_i32 v162, v162, 0, v4
    v_lshl_add_u32 v162, v162, 2, s68
    v_sub_u32 v167, v167, v163
    v_med3_i32 v163, v163, 0, v4
    v_lshl_add_u32 v163, v163, 2, s68
    ds_max_u32 v160, v164 offset:6128
    ds_max_u32 v161, v165 offset:6128
    ds_max_u32 v162, v166 offset:6128
    ds_max_u32 v163, v167 offset:6128
    ds_read_b128 v[44:47], v168 offset:6128
    ds_read_b128 v[48:51], v168 offset:6144
    s_lshl_b32 s3, s64, 3
    s_or_b32 s3, s3, s60
    v_mov_b32 v2, s3
    s_mov_b64 exec, 1
    ds_write_b32 v5, v2 offset:64
    s_mov_b64 exec, -1
    s_cmp_eq_u32 s69, 0
    s_cbranch_scc1 EXP_B
    ds_read_b128 v[204:207], v13 offset:49152
    ds_read_b128 v[208:211], v13 offset:50176
    ds_read_b128 v[212:215], v13 offset:51200
    ds_read_b128 v[216:219], v13 offset:52224
    ds_read_b128 v[220:223], v13 offset:57344
    ds_read_b128 v[224:227], v13 offset:58368
    ds_read_b128 v[228:231], v13 offset:59392
    ds_read_b128 v[232:235], v13 offset:60416
    s_waitcnt lgkmcnt(9)
    s_branch EXP_C
EXP_B:
    s_waitcnt lgkmcnt(1)
EXP_C:
    v_max3_u32 v3, v44, v45, v46
    v_max3_u32 v3, v3, v47, v48
    v_max3_u32 v3, v3, v49, v50
    v_max_u32 v3, v3, v51
    v_max_u32 v45, v44, v45
    v_max_u32 v46, v45, v46
    v_max_u32_dpp v3, v3, v3 row_shr:1 row_mask:0xf bank_mask:0xf
    v_max_u32 v47, v46, v47
    v_max_u32 v48, v47, v48
    v_max_u32_dpp v3, v3, v3 row_shr:2 row_mask:0xf bank_mask:0xf
    v_max_u32 v49, v48, v49
    v_max_u32 v50, v49, v50
    v_max_u32_dpp v3, v3, v3 row_shr:4 row_mask:0xf bank_mask:0xf
    v_max_u32 v51, v50, v51
    s_nop 0
    v_max_u32_dpp v3, v3, v3 row_shr:8 row_mask:0xf bank_mask:0xf
    s_nop 1
    v_max_u32_dpp v3, v3, v3 row_bcast:15 row_mask:0xa bank_mask:0xf
    s_nop 1
    v_max_u32_dpp v3, v3, v3 row_bcast:31 row_mask:0xc bank_mask:0xf
    s_nop 1
    v_mov_b32_dpp v170, v3 wave_shr:1 row_mask:0xf bank_mask:0xf
    v_max_u32 v44, v170, v44
    v_add3_u32 v44, v44, v171, 0
    v_max_u32 v45, v170, v45
    v_add3_u32 v45, v45, v171, 1
    v_max_u32 v46, v170, v46
    v_add3_u32 v46, v46, v171, 2
    v_max_u32 v47, v170, v47
    v_add3_u32 v47, v47, v171, 3
    v_max_u32 v48, v170, v48
    v_add3_u32 v48, v48, v171, 4
    v_max_u32 v49, v170, v49
    v_add3_u32 v49, v49, v171, 5
    v_max_u32 v50, v170, v50
    v_add3_u32 v50, v50, v171, 6
    v_max_u32 v51, v170, v51
    v_add3_u32 v51, v51, v171, 7
    ds_write_b128 v168, v[44:47] offset:6128
    ds_write_b128 v168, v[48:51] offset:6144
    v_lshrrev_b32 v11, 3, v0
    v_lshlrev_b32 v11, 2, v11
    v_and_b32 v12, 7, v0
    v_lshlrev_b32 v24, 3, v12
    v_lshlrev_b32 v12, 2, v12
    s_sub_u32 s3, 7, s60
    s_sub_u32 s97, s60, 4
    s_cmp_lt_u32 s60, 4
    s_cselect_b32 s97, s3, s97
    s_waitcnt lgkmcnt(0)
    s_cmp_eq_u32 s69, 0
    s_cbranch_scc1 LATER
    s_barrier
    ds_read_b32 v11, v11 offset:64
    ds_read_b32 v12, v12 offset:64
    ds_read_b128 v[140:143], v13 offset:16384
    ds_read_b128 v[144:147], v13 offset:17408
    ds_read_b128 v[148:151], v13 offset:18432
    ds_read_b128 v[152:155], v13 offset:19456
    s_waitcnt lgkmcnt(4)
    v_cmp_lt_u32 vcc, v12, v11
    ds_read_b128 v[156:159], v13 offset:24576
    ds_read_b128 v[160:163], v13 offset:25600
    v_lshrrev_b64 v[16:17], v24, vcc
    v_and_b32 v16, 0xff, v16
    v_bcnt_u32_b32 v16, v16, 0
    v_cmp_eq_u32 vcc, s97, v16
    s_ff1_i32_b64 s97, vcc
    v_readlane_b32 s64, v12, s97
    s_lshl_b32 s73, s97, 11
    s_add_u32 s73, s73, 66560
    s_lshl_b32 s68, s97, 13
    s_add_u32 s68, s68, 1024
    v_lshl_add_u32 v6, v0, 2, s68
    ds_read_b32 v14, v6 offset:6128
    ds_read_b32 v10, v6 offset:6384
    v_add_u32 v19, s73, v19
    v_xor_b32 v11, 32, v19
    v_xor_b32 v12, 64, v19
    v_xor_b32 v16, 96, v19
    ds_read_b128 v[236:239], v19
    ds_read_b128 v[240:243], v11
    ds_read_b128 v[244:247], v12
    ds_read_b128 v[248:251], v16
    ds_read_b128 v[164:167], v13 offset:26624
    ds_read_b128 v[168:171], v13 offset:27648
    v_add_u32 v18, s73, v18
    v_xor_b32 v11, 32, v18
    v_xor_b32 v12, 64, v18
    v_xor_b32 v16, 96, v18
    ds_read_b128 v[60:63], v18
    ds_read_b128 v[64:67], v11
    ds_read_b128 v[68:71], v12
    ds_read_b128 v[72:75], v16
    ds_read_b128 v[108:111], v13 offset:0
    ds_read_b128 v[112:115], v13 offset:1024
    ds_read_b128 v[116:119], v13 offset:2048
    ds_read_b128 v[120:123], v13 offset:3072
    ds_read_b128 v[124:127], v13 offset:8192
    ds_read_b128 v[128:131], v13 offset:9216
    ds_read_b128 v[132:135], v13 offset:10240
    ds_read_b128 v[136:139], v13 offset:11264
    v_lshlrev_b32 v76, 16, v52
    v_and_b32 v80, 0xffff0000, v52
    v_lshlrev_b32 v77, 16, v53
    v_and_b32 v81, 0xffff0000, v53
    v_lshlrev_b32 v78, 16, v54
    v_and_b32 v82, 0xffff0000, v54
    v_lshlrev_b32 v79, 16, v55
    v_and_b32 v83, 0xffff0000, v55
    v_mul_f32 v76, s92, v76
    v_mul_f32 v77, s92, v77
    v_mul_f32 v78, s92, v78
    v_mul_f32 v79, s92, v79
    v_mul_f32 v80, s92, v80
    v_mul_f32 v81, s92, v81
    v_mul_f32 v82, s92, v82
    v_mul_f32 v83, s92, v83
    v_cvt_pk_bf16_f32 v52, v76, v77
    v_cvt_pk_bf16_f32 v53, v78, v79
    v_cvt_pk_bf16_f32 v54, v80, v81
    v_cvt_pk_bf16_f32 v55, v82, v83
    s_lshr_b32 s64, s64, 3
    s_lshl_b32 s61, s70, 3
    s_add_u32 s61, s61, s97
    s_waitcnt lgkmcnt(12)
    v_mfma_f32_32x32x16_bf16 v[76:91], v[236:239], v[140:143], 0
    v_bfe_u32 v11, v0, 2, 2
    v_lshrrev_b32 v12, 5, v0
    v_lshl_or_b32 v11, v12, 3, v11
    v_lshl_add_u32 v2, v11, 4, s68
    v_and_b32 v11, 3, v0
    v_mfma_f32_32x32x16_bf16 v[76:91], v[240:243], v[144:147], v[76:91]
    v_add_u32 v3, v11, v2
    v_and_b32 v11, 31, v0
    v_lshl_add_u32 v4, v11, 4, s68
    v_lshl_add_u32 v5, v12, 2, v4
    v_lshl_add_u32 v7, v0, 4, s68
    v_mfma_f32_32x32x16_bf16 v[76:91], v[244:247], v[148:151], v[76:91]
    s_min_u32 s64, s64, s77
    s_sub_u32 s3, s64, s65
    s_min_u32 s3, s3, 512
    s_add_u32 s3, s3, 31
    s_bitcmp0_b32 s3, 4
    v_mfma_f32_32x32x16_bf16 v[76:91], v[248:251], v[152:155], v[76:91]
    s_cselect_b32 s90, 0, -1
    s_lshr_b32 s3, s3, 5
    s_max_u32 s3, s3, 1
    s_sub_u32 s66, s3, 1
    s_mov_b32 s72, 2
    v_mfma_f32_32x32x16_bf16 v[92:107], v[236:239], v[156:159], 0
    s_lshl_b32 s3, s61, 13
    s_add_u32 s3, s3, 670
    s_mul_hi_u32 s62, s3, s71
    s_lshr_b32 s62, s62, 9
    s_add_u32 s3, s3, 8192
    v_mfma_f32_32x32x16_bf16 v[92:107], v[240:243], v[160:163], v[92:107]
    s_mul_hi_u32 s63, s3, s71
    s_lshr_b32 s63, s63, 9
    s_min_u32 s63, s63, 25000
    s_sub_u32 s3, s63, s62
    s_lshl_b32 s3, s3, 7
    v_mfma_f32_32x32x16_bf16 v[92:107], v[244:247], v[164:167], v[92:107]
    s_lshl_b32 s97, s62, 7
    s_add_u32 s44, s22, s97
    s_addc_u32 s45, s23, 0
    s_and_b32 s45, s45, 0xffff
    s_mov_b32 s46, s3
    v_mfma_f32_32x32x16_bf16 v[92:107], v[248:251], v[168:171], v[92:107]
    s_mov_b32 s47, 0x20000
    s_waitcnt lgkmcnt(0)
    buffer_load_dwordx4 v[32:35], v14, s[40:43], 0 idxen
    buffer_load_dwordx4 v[44:47], v10, s[40:43], 0 idxen
    v_mfma_f32_32x32x16_bf16 v[140:155], v[60:63], v[108:111], 0
    v_mfma_f32_32x32x16_bf16 v[140:155], v[64:67], v[112:115], v[140:155]
    v_mfma_f32_32x32x16_bf16 v[140:155], v[68:71], v[116:119], v[140:155]
    v_mfma_f32_32x32x16_bf16 v[140:155], v[72:75], v[120:123], v[140:155]
    v_mfma_f32_32x32x16_bf16 v[156:171], v[60:63], v[124:127], 0
    v_mfma_f32_32x32x16_bf16 v[156:171], v[64:67], v[128:131], v[156:171]
    v_mfma_f32_32x32x16_bf16 v[156:171], v[68:71], v[132:135], v[156:171]
    v_mfma_f32_32x32x16_bf16 v[156:171], v[72:75], v[136:139], v[156:171]
    s_waitcnt lgkmcnt(0)
    s_barrier
    s_nop 3
    v_cvt_pk_bf16_f32 v36, v76, v92
    v_cvt_pk_bf16_f32 v37, v77, v93
    v_cvt_pk_bf16_f32 v38, v78, v94
    v_cvt_pk_bf16_f32 v39, v79, v95
    v_cvt_pk_bf16_f32 v40, v80, v96
    v_cvt_pk_bf16_f32 v41, v81, v97
    v_cvt_pk_bf16_f32 v42, v82, v98
    v_cvt_pk_bf16_f32 v43, v83, v99
    s_mov_b32 s3, 0x358637bd
    v_mov_b32 v76, s3
    v_mov_b32 v77, s3
    v_mov_b32 v78, s3
    v_mov_b32 v79, s3
    v_mov_b32 v80, s3
    v_mov_b32 v81, s3
    v_mov_b32 v82, s3
    v_mov_b32 v83, s3
    v_mov_b32 v84, 0
    v_mov_b32 v85, 0
    v_mov_b32 v86, 0
    v_mov_b32 v87, 0
    v_mov_b32 v88, 0
    v_mov_b32 v89, 0
    v_mov_b32 v90, 0
    v_mov_b32 v91, 0
    v_mov_b32 v92, s3
    v_mov_b32 v93, s3
    v_mov_b32 v94, s3
    v_mov_b32 v95, s3
    v_mov_b32 v96, s3
    v_mov_b32 v97, s3
    v_mov_b32 v98, s3
    v_mov_b32 v99, s3
    v_mov_b32 v100, 0
    v_mov_b32 v101, 0
    v_mov_b32 v102, 0
    v_mov_b32 v103, 0
    v_mov_b32 v104, 0
    v_mov_b32 v105, 0
    v_mov_b32 v106, 0
    v_mov_b32 v107, 0
    v_cvt_pk_bf16_f32 v236, 0, v141
    v_cvt_pk_bf16_f32 v237, v142, v143
    v_cvt_pk_bf16_f32 v238, 0, v145
    v_cvt_pk_bf16_f32 v239, v146, v147
    v_cvt_pk_bf16_f32 v240, 0, v149
    v_cvt_pk_bf16_f32 v241, v150, v151
    v_cvt_pk_bf16_f32 v242, 0, v153
    v_cvt_pk_bf16_f32 v243, v154, v155
    v_cvt_pk_bf16_f32 v244, 0, v157
    v_cvt_pk_bf16_f32 v245, v158, v159
    v_cvt_pk_bf16_f32 v246, 0, v161
    v_cvt_pk_bf16_f32 v247, v162, v163
    v_cvt_pk_bf16_f32 v248, 0, v165
    v_cvt_pk_bf16_f32 v249, v166, v167
    v_cvt_pk_bf16_f32 v250, 0, v169
    v_cvt_pk_bf16_f32 v251, v170, v171
    s_mov_b32 exec_hi, 0
    v_mov_b32 v236, v52
    v_mov_b32 v240, v53
    v_mov_b32 v244, v54
    v_mov_b32 v248, v55
    s_mov_b64 exec, -1
NOW:
    s_mov_b32 m0, s67
    s_waitcnt vmcnt(1)
    v_cmp_gt_u32 s[4:5], s77, v14
FX0:
    v_cmp_ne_u32 vcc, s74, v35
    v_cmp_ne_u32_sdwa s[6:7], v34, s87 src0_sel:BYTE_3 src1_sel:DWORD
    v_bfe_u32 v11, v34, 16, 8
    s_or_b64 vcc, vcc, s[6:7]
    s_and_b64 vcc, vcc, s[4:5]
    s_cbranch_scc1 FX0_R
    v_xor_b32 v34, 0xffff, v34
    ds_write_b128 v7, v[32:35] offset:0
    ds_read_u16 v20, v2 offset:8
    ds_read_u16 v22, v2 offset:72
    ds_read_u16 v24, v2 offset:264
    ds_read_u16 v26, v2 offset:328
    ds_read_b32 v12, v11 offset:256
    ds_read_b32 v35, v11 offset:260
    ds_read_b32 v14, v6 offset:6640
    s_waitcnt lgkmcnt(3)
    buffer_load_dwordx4 v[20:21], s[32:35], s84 idxen offen offset:0 lds
    buffer_load_dwordx4 v[22:23], s[32:35], s85 idxen offen offset:1024 lds
    buffer_load_dwordx4 v[24:25], s[32:35], s86 idxen offen offset:2048 lds
    buffer_load_dwordx4 v[26:27], s[32:35], 0 idxen offen offset:3072 lds
    ds_read_u16 v20, v2 offset:520
    ds_read_u16 v22, v2 offset:584
    ds_read_u16 v24, v2 offset:776
    ds_read_u16 v26, v2 offset:840
    s_cmp_eq_u32 s69, 0
    s_cbranch_scc1 NOW2
NOW2:
    s_waitcnt vmcnt(4)
    v_cmp_gt_u32 s[4:5], s77, v10
FX1:
    v_cmp_ne_u32 vcc, s74, v47
    v_cmp_ne_u32_sdwa s[6:7], v46, s87 src0_sel:BYTE_3 src1_sel:DWORD
    v_bfe_u32 v11, v46, 16, 8
    s_or_b64 vcc, vcc, s[6:7]
    s_and_b64 vcc, vcc, s[4:5]
    s_cbranch_scc1 FX1_R
    ds_read_b32 v13, v11 offset:256
    ds_read_b32 v47, v11 offset:260
    s_waitcnt lgkmcnt(2)
    v_bitop3_b32 v34, v12, v34, s79 bitop3:0xd8
    ds_write_b64 v7, v[34:35] offset:8
    ds_read_b32 v28, v5 offset:0
    ds_read_b32 v10, v4 offset:8
    s_add_u32 m0, s67, 4096
    s_cmp_eq_u32 s69, 0
    s_cbranch_scc1 NOW3
NOW3:
    s_waitcnt lgkmcnt(2)
    v_bitop3_b32 v46, v13, v46, s79 bitop3:0x72
    ds_write_b128 v7, v[44:47] offset:1024
    s_waitcnt vmcnt(0)
    ds_read_b128 v[60:63], v8 offset:0
    ds_read_b128 v[64:67], v9 offset:0
    ds_read_b128 v[68:71], v8 offset:256
    ds_read_b128 v[72:75], v9 offset:256
    buffer_load_dwordx4 v[20:21], s[32:35], s84 idxen offen offset:0 lds
    buffer_load_dwordx4 v[22:23], s[32:35], s85 idxen offen offset:1024 lds
    buffer_load_dwordx4 v[24:25], s[32:35], s86 idxen offen offset:2048 lds
    buffer_load_dwordx4 v[26:27], s[32:35], 0 idxen offen offset:3072 lds
    buffer_load_dwordx4 v[32:35], v14, s[40:43], 0 idxen
    ds_read_u16 v20, v2 offset:1032
    ds_read_u16 v22, v2 offset:1096
    ds_read_u16 v24, v2 offset:1288
    ds_read_u16 v26, v2 offset:1352
    s_add_u32 m0, s67, 0
    s_waitcnt lgkmcnt(7)
    v_mfma_f32_32x32x16_bf16 v[108:123], v[60:63], v[172:175], 0
    s_waitcnt lgkmcnt(6)
    v_mfma_f32_32x32x16_bf16 v[108:123], v[64:67], v[176:179], v[108:123]
    s_waitcnt lgkmcnt(5)
    v_mfma_f32_32x32x16_bf16 v[108:123], v[68:71], v[180:183], v[108:123]
    s_waitcnt lgkmcnt(0)
    v_mfma_f32_32x32x16_bf16 v[108:123], v[72:75], v[184:187], v[108:123]
    buffer_load_dwordx4 v[20:21], s[32:35], s84 idxen offen offset:0 lds
    v_smfmac_f32_32x32x32_bf16 v[108:123], v[28:31], v[236:243], v10 abid:1
    buffer_load_dwordx4 v[22:23], s[32:35], s85 idxen offen offset:1024 lds
    s_nop 6
    v_mfma_f32_32x32x16_bf16 v[124:139], v[60:63], v[204:207], 0
    s_setprio 1
    ds_read_u8 v16, v3 offset:12
    buffer_load_dwordx4 v[24:25], s[32:35], s86 idxen offen offset:2048 lds
    ds_read_u8 v17, v3 offset:76
    v_exp_f32 v108, v108
    v_exp_f32 v109, v109
    v_mfma_f32_32x32x16_bf16 v[124:139], v[64:67], v[208:211], v[124:139]
    buffer_load_dwordx4 v[26:27], s[32:35], 0 idxen offen offset:3072 lds
    v_exp_f32 v110, v110
    v_exp_f32 v111, v111
    v_mfma_f32_32x32x16_bf16 v[124:139], v[68:71], v[212:215], v[124:139]
    ds_read_u8 v18, v3 offset:268
    v_exp_f32 v112, v112
    v_exp_f32 v113, v113
    v_mfma_f32_32x32x16_bf16 v[124:139], v[72:75], v[216:219], v[124:139]
    s_setprio 3
    ds_read_u8 v19, v3 offset:332
    v_exp_f32 v114, v114
    v_exp_f32 v115, v115
    v_pk_add_f32 v[108:109], v[108:109], 1.0 op_sel_hi:[1,0]
    v_pk_add_f32 v[110:111], v[110:111], 1.0 op_sel_hi:[1,0]
    v_pk_add_f32 v[112:113], v[112:113], 1.0 op_sel_hi:[1,0]
    v_pk_add_f32 v[114:115], v[114:115], 1.0 op_sel_hi:[1,0]
    v_mfma_f32_32x32x16_bf16 v[140:155], v[60:63], v[188:191], 0
    s_setprio 1
    ds_read_u16 v20, v2 offset:1544
    v_rcp_f32 v52, v108
    v_exp_f32 v116, v116
    v_rcp_f32 v53, v109
    v_mfma_f32_32x32x16_bf16 v[140:155], v[64:67], v[192:195], v[140:155]
    ds_read_u16 v22, v2 offset:1608
    v_exp_f32 v117, v117
    v_rcp_f32 v54, v110
    v_exp_f32 v118, v118
    v_mfma_f32_32x32x16_bf16 v[140:155], v[68:71], v[196:199], v[140:155]
    ds_read_u16 v24, v2 offset:1800
    v_rcp_f32 v55, v111
    v_exp_f32 v119, v119
    v_rcp_f32 v56, v112
    v_mfma_f32_32x32x16_bf16 v[140:155], v[72:75], v[200:203], v[140:155]
    ds_read_u16 v26, v2 offset:1864
    v_exp_f32 v120, v120
    v_rcp_f32 v57, v113
    v_exp_f32 v121, v121
    v_smfmac_f32_32x32x32_bf16 v[140:155], v[28:31], v[244:251], v10 abid:1
    s_setprio 3
    ds_read_b32 v28, v5 offset:512
    v_rcp_f32 v58, v114
    v_exp_f32 v122, v122
    v_rcp_f32 v59, v115
    v_exp_f32 v123, v123
    v_pk_mul_f32 v[124:125], v[124:125], v[52:53]
    v_pk_mul_f32 v[126:127], v[126:127], v[54:55]
    v_pk_mul_f32 v[128:129], v[128:129], v[56:57]
    v_pk_mul_f32 v[130:131], v[130:131], v[58:59]
    v_pk_add_f32 v[116:117], v[116:117], 1.0 op_sel_hi:[1,0]
    v_pk_add_f32 v[118:119], v[118:119], 1.0 op_sel_hi:[1,0]
    v_pk_add_f32 v[120:121], v[120:121], 1.0 op_sel_hi:[1,0]
    v_pk_add_f32 v[122:123], v[122:123], 1.0 op_sel_hi:[1,0]
    v_mfma_f32_32x32x16_bf16 v[156:171], v[60:63], v[220:223], 0
    s_setprio 1
    ds_read_b32 v10, v4 offset:520
    s_waitcnt vmcnt(4) lgkmcnt(2)
    ds_read_b64_tr_b16 v[44:45], v16 offset:0
    ds_read_b128 v[60:63], v8 offset:4096
    v_cvt_pk_bf16_f32 v124, v52, v124
    v_rcp_f32 v52, v116
    v_exp_f32 v140, v140
    v_cvt_pk_bf16_f32 v125, v53, v125
    v_mfma_f32_32x32x16_bf16 v[156:171], v[64:67], v[224:227], v[156:171]
    ds_read_b128 v[64:67], v9 offset:4096
    v_rcp_f32 v53, v117
    v_exp_f32 v141, v141
    v_cvt_pk_bf16_f32 v126, v54, v126
    v_rcp_f32 v54, v118
    v_mfma_f32_32x32x16_bf16 v[156:171], v[68:71], v[228:231], v[156:171]
    ds_read_b128 v[68:71], v8 offset:4352
    v_exp_f32 v142, v142
    v_cvt_pk_bf16_f32 v127, v55, v127
    v_rcp_f32 v55, v119
    v_exp_f32 v143, v143
    v_mfma_f32_32x32x16_bf16 v[156:171], v[72:75], v[232:235], v[156:171]
    s_setprio 3
    s_waitcnt lgkmcnt(1)
    ds_read_b128 v[72:75], v9 offset:4352
    v_cvt_pk_bf16_f32 v128, v56, v128
    v_rcp_f32 v56, v120
    v_exp_f32 v144, v144
    v_cvt_pk_bf16_f32 v129, v57, v129
    v_rcp_f32 v57, v121
    v_exp_f32 v145, v145
    v_cvt_pk_bf16_f32 v130, v58, v130
    v_rcp_f32 v58, v122
    v_exp_f32 v146, v146
    v_cvt_pk_bf16_f32 v131, v59, v131
    v_rcp_f32 v59, v123
    v_exp_f32 v147, v147
    v_cmp_gt_u32 s[4:5], s77, v14
FXP:
    v_cmp_ne_u32 vcc, s74, v35
    v_cmp_ne_u32_sdwa s[6:7], v34, s87 src0_sel:BYTE_3 src1_sel:DWORD
    v_bfe_u32 v11, v34, 16, 8
    s_or_b64 vcc, vcc, s[6:7]
    s_and_b64 vcc, vcc, s[4:5]
    s_cbranch_scc1 FXP_R
    s_sub_u32 s66, s66, 1
    v_pk_mul_f32 v[132:133], v[132:133], v[52:53]
    v_pk_mul_f32 v[134:135], v[134:135], v[54:55]
    v_pk_mul_f32 v[136:137], v[136:137], v[56:57]
    v_pk_mul_f32 v[138:139], v[138:139], v[58:59]
    v_pk_add_f32 v[140:141], v[140:141], 1.0 op_sel_hi:[1,0]
    v_pk_add_f32 v[142:143], v[142:143], 1.0 op_sel_hi:[1,0]
    v_pk_add_f32 v[144:145], v[144:145], 1.0 op_sel_hi:[1,0]
    v_pk_add_f32 v[146:147], v[146:147], 1.0 op_sel_hi:[1,0]
    s_cbranch_scc1 TAIL
    v_mfma_f32_32x32x16_bf16 v[108:123], v[60:63], v[172:175], 0
    s_setprio 1
    s_add_u32 s72, s72, 1
    ds_read_b64_tr_b16 v[46:47], v17 offset:0
    ds_read_b32 v12, v11 offset:256
    v_cvt_pk_bf16_f32 v132, v52, v132
    v_rcp_f32 v52, v140
    v_exp_f32 v148, v148
    v_cvt_pk_bf16_f32 v133, v53, v133
    v_mfma_f32_32x32x16_bf16 v[108:123], v[64:67], v[176:179], v[108:123]
    s_waitcnt lgkmcnt(2)
    ds_read_b64_tr_b16 v[48:49], v18 offset:0
    ds_read_b32 v35, v11 offset:260
    v_rcp_f32 v53, v141
    v_exp_f32 v149, v149
    v_cvt_pk_bf16_f32 v134, v54, v134
    v_rcp_f32 v54, v142
    v_exp_f32 v150, v150
    v_mfma_f32_32x32x16_bf16 v[108:123], v[68:71], v[180:183], v[108:123]
    s_add_u32 m0, s67, 4096
    ds_read_b64_tr_b16 v[50:51], v19 offset:0
    ds_read_b32 v14, v6 offset:6896
    v_cvt_pk_bf16_f32 v135, v55, v135
    v_rcp_f32 v55, v143
    v_exp_f32 v151, v151
    v_cvt_pk_bf16_f32 v136, v56, v136
    v_mfma_f32_32x32x16_bf16 v[108:123], v[72:75], v[184:187], v[108:123]
    s_or_b32 s3, s66, s90
    buffer_load_dwordx4 v[20:21], s[32:35], s84 idxen offen offset:0 lds
    v_rcp_f32 v56, v144
    v_exp_f32 v152, v152
    v_cvt_pk_bf16_f32 v137, v57, v137
    v_rcp_f32 v57, v145
    v_exp_f32 v153, v153
    v_smfmac_f32_32x32x32_bf16 v[108:123], v[28:31], v[236:243], v10 abid:1
    s_setprio 3
    s_waitcnt lgkmcnt(1)
    buffer_load_dwordx4 v[22:23], s[32:35], s85 idxen offen offset:1024 lds
    v_cvt_pk_bf16_f32 v138, v58, v138
    v_rcp_f32 v58, v146
    v_exp_f32 v154, v154
    v_cvt_pk_bf16_f32 v139, v59, v139
    v_rcp_f32 v59, v147
    v_exp_f32 v155, v155
    v_bitop3_b32 v34, v12, v34, s79 bitop3:0x72
    v_pk_mul_f32 v[156:157], v[156:157], v[52:53]
    v_pk_mul_f32 v[158:159], v[158:159], v[54:55]
    v_pk_mul_f32 v[160:161], v[160:161], v[56:57]
    v_pk_mul_f32 v[162:163], v[162:163], v[58:59]
    v_pk_add_f32 v[148:149], v[148:149], 1.0 op_sel_hi:[1,0]
    v_pk_add_f32 v[150:151], v[150:151], 1.0 op_sel_hi:[1,0]
    v_pk_add_f32 v[152:153], v[152:153], 1.0 op_sel_hi:[1,0]
    v_pk_add_f32 v[154:155], v[154:155], 1.0 op_sel_hi:[1,0]
    s_branch MID
.p2align 3
LOOP:
    v_smfmac_f32_32x32x32_bf16 v[76:91], v[44:47], v[124:131], v1
    s_setprio 1
    v_cvt_pk_bf16_f32 v156, v52, v156
    v_rcp_f32 v52, v148
    v_exp_f32 v108, v108
    v_smfmac_f32_32x32x32_bf16 v[76:91], v[48:51], v[132:139], v1
    ds_read_u8 v16, v3 offset:12
    v_cvt_pk_bf16_f32 v157, v53, v157
    v_rcp_f32 v53, v149
    v_exp_f32 v109, v109
    v_mfma_f32_32x32x16_bf16 v[124:139], v[60:63], v[204:207], 0
    buffer_load_dwordx4 v[24:25], s[32:35], s86 idxen offen offset:2048 lds
    ds_read_u8 v17, v3 offset:76
    v_cvt_pk_bf16_f32 v158, v54, v158
    v_rcp_f32 v54, v150
    v_exp_f32 v110, v110
    v_cvt_pk_bf16_f32 v159, v55, v159
    v_mfma_f32_32x32x16_bf16 v[124:139], v[64:67], v[208:211], v[124:139]
    buffer_load_dwordx4 v[26:27], s[32:35], 0 idxen offen offset:3072 lds
    v_rcp_f32 v55, v151
    v_exp_f32 v111, v111
    v_cvt_pk_bf16_f32 v160, v56, v160
    v_rcp_f32 v56, v152
    v_mfma_f32_32x32x16_bf16 v[124:139], v[68:71], v[212:215], v[124:139]
    ds_read_u8 v18, v3 offset:268
    v_exp_f32 v112, v112
    v_cvt_pk_bf16_f32 v161, v57, v161
    v_rcp_f32 v57, v153
    v_exp_f32 v113, v113
    v_mfma_f32_32x32x16_bf16 v[124:139], v[72:75], v[216:219], v[124:139]
    s_setprio 3
    ds_read_u8 v19, v3 offset:332
    v_cvt_pk_bf16_f32 v162, v58, v162
    v_rcp_f32 v58, v154
    v_exp_f32 v114, v114
    v_cvt_pk_bf16_f32 v163, v59, v163
    v_rcp_f32 v59, v155
    v_exp_f32 v115, v115
    v_pk_mul_f32 v[164:165], v[164:165], v[52:53]
    v_pk_mul_f32 v[166:167], v[166:167], v[54:55]
    v_pk_mul_f32 v[168:169], v[168:169], v[56:57]
    v_pk_mul_f32 v[170:171], v[170:171], v[58:59]
    v_pk_add_f32 v[108:109], v[108:109], 1.0 op_sel_hi:[1,0]
    v_pk_add_f32 v[110:111], v[110:111], 1.0 op_sel_hi:[1,0]
    v_pk_add_f32 v[112:113], v[112:113], 1.0 op_sel_hi:[1,0]
    v_pk_add_f32 v[114:115], v[114:115], 1.0 op_sel_hi:[1,0]
    v_mfma_f32_32x32x16_bf16 v[140:155], v[60:63], v[188:191], 0
    s_setprio 1
    ds_read_u16 v20, v2 offset:1544
    v_cvt_pk_bf16_f32 v164, v52, v164
    v_rcp_f32 v52, v108
    v_exp_f32 v116, v116
    v_cvt_pk_bf16_f32 v165, v53, v165
    v_mfma_f32_32x32x16_bf16 v[140:155], v[64:67], v[192:195], v[140:155]
    ds_read_u16 v22, v2 offset:1608
    v_rcp_f32 v53, v109
    v_exp_f32 v117, v117
    v_cvt_pk_bf16_f32 v166, v54, v166
    v_rcp_f32 v54, v110
    v_exp_f32 v118, v118
    v_mfma_f32_32x32x16_bf16 v[140:155], v[68:71], v[196:199], v[140:155]
    ds_read_u16 v24, v2 offset:1800
    v_cvt_pk_bf16_f32 v167, v55, v167
    v_rcp_f32 v55, v111
    v_exp_f32 v119, v119
    v_cvt_pk_bf16_f32 v168, v56, v168
    v_mfma_f32_32x32x16_bf16 v[140:155], v[72:75], v[200:203], v[140:155]
    ds_read_u16 v26, v2 offset:1864
    v_rcp_f32 v56, v112
    v_exp_f32 v120, v120
    v_cvt_pk_bf16_f32 v169, v57, v169
    v_rcp_f32 v57, v113
    v_exp_f32 v121, v121
    v_smfmac_f32_32x32x32_bf16 v[140:155], v[28:31], v[244:251], v10 abid:1
    s_setprio 3
    ds_read_b32 v28, v5 offset:512
    v_cvt_pk_bf16_f32 v170, v58, v170
    v_rcp_f32 v58, v114
    v_exp_f32 v122, v122
    v_cvt_pk_bf16_f32 v171, v59, v171
    v_rcp_f32 v59, v115
    v_exp_f32 v123, v123
    v_pk_mul_f32 v[124:125], v[124:125], v[52:53]
    v_pk_mul_f32 v[126:127], v[126:127], v[54:55]
    v_pk_mul_f32 v[128:129], v[128:129], v[56:57]
    v_pk_mul_f32 v[130:131], v[130:131], v[58:59]
    v_pk_add_f32 v[116:117], v[116:117], 1.0 op_sel_hi:[1,0]
    v_pk_add_f32 v[118:119], v[118:119], 1.0 op_sel_hi:[1,0]
    v_pk_add_f32 v[120:121], v[120:121], 1.0 op_sel_hi:[1,0]
    v_pk_add_f32 v[122:123], v[122:123], 1.0 op_sel_hi:[1,0]
    v_smfmac_f32_32x32x32_bf16 v[92:107], v[44:47], v[156:163], v1
    s_setprio 1
    ds_read_b32 v10, v4 offset:520
    v_cvt_pk_bf16_f32 v124, v52, v124
    v_rcp_f32 v52, v116
    v_exp_f32 v140, v140
    v_smfmac_f32_32x32x32_bf16 v[92:107], v[48:51], v[164:171], v1
    s_waitcnt vmcnt(4) lgkmcnt(2)
    ds_read_b64_tr_b16 v[44:45], v16 offset:0
    v_cvt_pk_bf16_f32 v125, v53, v125
    v_rcp_f32 v53, v117
    v_exp_f32 v141, v141
    v_mfma_f32_32x32x16_bf16 v[156:171], v[60:63], v[220:223], 0
    ds_read_b128 v[60:63], v8 offset:4096
    v_cvt_pk_bf16_f32 v126, v54, v126
    v_rcp_f32 v54, v118
    v_exp_f32 v142, v142
    v_cvt_pk_bf16_f32 v127, v55, v127
    v_mfma_f32_32x32x16_bf16 v[156:171], v[64:67], v[224:227], v[156:171]
    s_cmp_gt_u32 s72, 7
    ds_read_b128 v[64:67], v9 offset:4096
    v_rcp_f32 v55, v119
    v_exp_f32 v143, v143
    v_cvt_pk_bf16_f32 v128, v56, v128
    v_rcp_f32 v56, v120
    v_mfma_f32_32x32x16_bf16 v[156:171], v[68:71], v[228:231], v[156:171]
    s_cselect_b32 s77, 0, s77
    ds_read_b128 v[68:71], v8 offset:4352
    v_exp_f32 v144, v144
    v_cvt_pk_bf16_f32 v129, v57, v129
    v_rcp_f32 v57, v121
    v_exp_f32 v145, v145
    v_mfma_f32_32x32x16_bf16 v[156:171], v[72:75], v[232:235], v[156:171]
    s_setprio 3
    s_waitcnt lgkmcnt(1)
    ds_read_b128 v[72:75], v9 offset:4352
    v_cvt_pk_bf16_f32 v130, v58, v130
    v_rcp_f32 v58, v122
    v_exp_f32 v146, v146
    v_cvt_pk_bf16_f32 v131, v59, v131
    v_rcp_f32 v59, v123
    v_exp_f32 v147, v147
    v_cmp_gt_u32 s[4:5], s77, v14
FXL:
    v_cmp_ne_u32 vcc, s74, v35
    v_cmp_ne_u32_sdwa s[6:7], v34, s87 src0_sel:BYTE_3 src1_sel:DWORD
    v_bfe_u32 v11, v34, 16, 8
    s_or_b64 vcc, vcc, s[6:7]
    s_and_b64 vcc, vcc, s[4:5]
    s_cbranch_scc1 FXL_R
    s_sub_u32 s66, s66, 1
    v_pk_mul_f32 v[132:133], v[132:133], v[52:53]
    v_pk_mul_f32 v[134:135], v[134:135], v[54:55]
    v_pk_mul_f32 v[136:137], v[136:137], v[56:57]
    v_pk_mul_f32 v[138:139], v[138:139], v[58:59]
    v_pk_add_f32 v[140:141], v[140:141], 1.0 op_sel_hi:[1,0]
    v_pk_add_f32 v[142:143], v[142:143], 1.0 op_sel_hi:[1,0]
    v_pk_add_f32 v[144:145], v[144:145], 1.0 op_sel_hi:[1,0]
    v_pk_add_f32 v[146:147], v[146:147], 1.0 op_sel_hi:[1,0]
    s_cbranch_scc1 TAIL
    v_mfma_f32_32x32x16_bf16 v[108:123], v[60:63], v[172:175], 0
    s_setprio 1
    s_add_u32 s72, s72, 1
    ds_read_b64_tr_b16 v[46:47], v17 offset:0
    ds_read_b32 v12, v11 offset:256
    v_cvt_pk_bf16_f32 v132, v52, v132
    v_rcp_f32 v52, v140
    v_exp_f32 v148, v148
    v_cvt_pk_bf16_f32 v133, v53, v133
    v_mfma_f32_32x32x16_bf16 v[108:123], v[64:67], v[176:179], v[108:123]
    s_waitcnt lgkmcnt(2)
    ds_read_b64_tr_b16 v[48:49], v18 offset:0
    ds_read_b32 v35, v11 offset:260
    v_rcp_f32 v53, v141
    v_exp_f32 v149, v149
    v_cvt_pk_bf16_f32 v134, v54, v134
    v_rcp_f32 v54, v142
    v_exp_f32 v150, v150
    v_mfma_f32_32x32x16_bf16 v[108:123], v[68:71], v[180:183], v[108:123]
    s_add_u32 m0, s67, 4096
    ds_read_b64_tr_b16 v[50:51], v19 offset:0
    ds_read_b32 v14, v6 offset:6896
    v_cvt_pk_bf16_f32 v135, v55, v135
    v_rcp_f32 v55, v143
    v_exp_f32 v151, v151
    v_cvt_pk_bf16_f32 v136, v56, v136
    v_mfma_f32_32x32x16_bf16 v[108:123], v[72:75], v[184:187], v[108:123]
    s_or_b32 s3, s66, s90
    buffer_load_dwordx4 v[20:21], s[32:35], s84 idxen offen offset:0 lds
    v_rcp_f32 v56, v144
    v_exp_f32 v152, v152
    v_cvt_pk_bf16_f32 v137, v57, v137
    v_rcp_f32 v57, v145
    v_exp_f32 v153, v153
    v_smfmac_f32_32x32x32_bf16 v[108:123], v[28:31], v[236:243], v10 abid:1
    s_setprio 3
    s_waitcnt lgkmcnt(1)
    buffer_load_dwordx4 v[22:23], s[32:35], s85 idxen offen offset:1024 lds
    v_cvt_pk_bf16_f32 v138, v58, v138
    v_rcp_f32 v58, v146
    v_exp_f32 v154, v154
    v_cvt_pk_bf16_f32 v139, v59, v139
    v_rcp_f32 v59, v147
    v_exp_f32 v155, v155
    v_bitop3_b32 v34, v12, v34, s79 bitop3:0x72
    v_pk_mul_f32 v[156:157], v[156:157], v[52:53]
    v_pk_mul_f32 v[158:159], v[158:159], v[54:55]
    v_pk_mul_f32 v[160:161], v[160:161], v[56:57]
    v_pk_mul_f32 v[162:163], v[162:163], v[58:59]
    v_pk_add_f32 v[148:149], v[148:149], 1.0 op_sel_hi:[1,0]
    v_pk_add_f32 v[150:151], v[150:151], 1.0 op_sel_hi:[1,0]
    v_pk_add_f32 v[152:153], v[152:153], 1.0 op_sel_hi:[1,0]
    v_pk_add_f32 v[154:155], v[154:155], 1.0 op_sel_hi:[1,0]
MID:
    s_cbranch_scc0 HALF1
    v_smfmac_f32_32x32x32_bf16 v[76:91], v[44:47], v[124:131], v1
    s_setprio 1
    s_cmp_eq_u32 s77, 0
    v_cvt_pk_bf16_f32 v156, v52, v156
    v_rcp_f32 v52, v148
    v_exp_f32 v108, v108
    v_smfmac_f32_32x32x32_bf16 v[76:91], v[48:51], v[132:139], v1
    s_cbranch_scc1 WR_S
    ds_write_b128 v7, v[32:35] offset:2048
WR_S:
    ds_read_u8 v16, v3 offset:524
    v_cvt_pk_bf16_f32 v157, v53, v157
    v_rcp_f32 v53, v149
    v_exp_f32 v109, v109
    v_mfma_f32_32x32x16_bf16 v[124:139], v[60:63], v[204:207], 0
    buffer_load_dwordx4 v[24:25], s[32:35], s86 idxen offen offset:2048 lds
    ds_read_u8 v17, v3 offset:588
    v_cvt_pk_bf16_f32 v158, v54, v158
    v_rcp_f32 v54, v150
    v_exp_f32 v110, v110
    v_cvt_pk_bf16_f32 v159, v55, v159
    v_mfma_f32_32x32x16_bf16 v[124:139], v[64:67], v[208:211], v[124:139]
    buffer_load_dwordx4 v[26:27], s[32:35], 0 idxen offen offset:3072 lds
    v_rcp_f32 v55, v151
    v_exp_f32 v111, v111
    v_cvt_pk_bf16_f32 v160, v56, v160
    v_rcp_f32 v56, v152
    v_mfma_f32_32x32x16_bf16 v[124:139], v[68:71], v[212:215], v[124:139]
    s_waitcnt lgkmcnt(1)
    buffer_load_dwordx4 v[32:35], v14, s[40:43], 0 idxen
    ds_read_u8 v18, v3 offset:780
    v_exp_f32 v112, v112
    v_cvt_pk_bf16_f32 v161, v57, v161
    v_rcp_f32 v57, v153
    v_exp_f32 v113, v113
    v_mfma_f32_32x32x16_bf16 v[124:139], v[72:75], v[216:219], v[124:139]
    s_setprio 3
    ds_read_u8 v19, v3 offset:844
    v_cvt_pk_bf16_f32 v162, v58, v162
    v_rcp_f32 v58, v154
    v_exp_f32 v114, v114
    v_cvt_pk_bf16_f32 v163, v59, v163
    v_rcp_f32 v59, v155
    v_exp_f32 v115, v115
    v_pk_mul_f32 v[164:165], v[164:165], v[52:53]
    v_pk_mul_f32 v[166:167], v[166:167], v[54:55]
    v_pk_mul_f32 v[168:169], v[168:169], v[56:57]
    v_pk_mul_f32 v[170:171], v[170:171], v[58:59]
    v_pk_add_f32 v[108:109], v[108:109], 1.0 op_sel_hi:[1,0]
    v_pk_add_f32 v[110:111], v[110:111], 1.0 op_sel_hi:[1,0]
    v_pk_add_f32 v[112:113], v[112:113], 1.0 op_sel_hi:[1,0]
    v_pk_add_f32 v[114:115], v[114:115], 1.0 op_sel_hi:[1,0]
    v_mfma_f32_32x32x16_bf16 v[140:155], v[60:63], v[188:191], 0
    s_setprio 1
    ds_read_u16 v20, v2 offset:2056
    v_cvt_pk_bf16_f32 v164, v52, v164
    v_rcp_f32 v52, v108
    v_exp_f32 v116, v116
    v_cvt_pk_bf16_f32 v165, v53, v165
    v_mfma_f32_32x32x16_bf16 v[140:155], v[64:67], v[192:195], v[140:155]
    ds_read_u16 v22, v2 offset:2120
    v_rcp_f32 v53, v109
    v_exp_f32 v117, v117
    v_cvt_pk_bf16_f32 v166, v54, v166
    v_rcp_f32 v54, v110
    v_exp_f32 v118, v118
    v_mfma_f32_32x32x16_bf16 v[140:155], v[68:71], v[196:199], v[140:155]
    ds_read_u16 v24, v2 offset:2312
    v_cvt_pk_bf16_f32 v167, v55, v167
    v_rcp_f32 v55, v111
    v_exp_f32 v119, v119
    v_cvt_pk_bf16_f32 v168, v56, v168
    v_mfma_f32_32x32x16_bf16 v[140:155], v[72:75], v[200:203], v[140:155]
    ds_read_u16 v26, v2 offset:2376
    v_rcp_f32 v56, v112
    v_exp_f32 v120, v120
    v_cvt_pk_bf16_f32 v169, v57, v169
    v_rcp_f32 v57, v113
    v_exp_f32 v121, v121
    v_smfmac_f32_32x32x32_bf16 v[140:155], v[28:31], v[244:251], v10 abid:1
    s_setprio 3
    ds_read_b32 v28, v5 offset:1024
    v_cvt_pk_bf16_f32 v170, v58, v170
    v_rcp_f32 v58, v114
    v_exp_f32 v122, v122
    v_cvt_pk_bf16_f32 v171, v59, v171
    v_rcp_f32 v59, v115
    v_exp_f32 v123, v123
    v_pk_mul_f32 v[124:125], v[124:125], v[52:53]
    v_pk_mul_f32 v[126:127], v[126:127], v[54:55]
    v_pk_mul_f32 v[128:129], v[128:129], v[56:57]
    v_pk_mul_f32 v[130:131], v[130:131], v[58:59]
    v_pk_add_f32 v[116:117], v[116:117], 1.0 op_sel_hi:[1,0]
    v_pk_add_f32 v[118:119], v[118:119], 1.0 op_sel_hi:[1,0]
    v_pk_add_f32 v[120:121], v[120:121], 1.0 op_sel_hi:[1,0]
    v_pk_add_f32 v[122:123], v[122:123], 1.0 op_sel_hi:[1,0]
    v_smfmac_f32_32x32x32_bf16 v[92:107], v[44:47], v[156:163], v1
    s_setprio 1
    ds_read_b32 v10, v4 offset:1032
    v_cvt_pk_bf16_f32 v124, v52, v124
    v_rcp_f32 v52, v116
    v_exp_f32 v140, v140
    v_smfmac_f32_32x32x32_bf16 v[92:107], v[48:51], v[164:171], v1
    s_waitcnt vmcnt(5) lgkmcnt(2)
    ds_read_b64_tr_b16 v[44:45], v16 offset:0
    v_cvt_pk_bf16_f32 v125, v53, v125
    v_rcp_f32 v53, v117
    v_exp_f32 v141, v141
    v_mfma_f32_32x32x16_bf16 v[156:171], v[60:63], v[220:223], 0
    ds_read_b128 v[60:63], v8 offset:0
    v_cvt_pk_bf16_f32 v126, v54, v126
    v_rcp_f32 v54, v118
    v_exp_f32 v142, v142
    v_cvt_pk_bf16_f32 v127, v55, v127
    v_mfma_f32_32x32x16_bf16 v[156:171], v[64:67], v[224:227], v[156:171]
    ds_read_b128 v[64:67], v9 offset:0
    v_rcp_f32 v55, v119
    v_exp_f32 v143, v143
    v_cvt_pk_bf16_f32 v128, v56, v128
    v_rcp_f32 v56, v120
    v_mfma_f32_32x32x16_bf16 v[156:171], v[68:71], v[228:231], v[156:171]
    s_sub_u32 s66, s66, 1
    ds_read_b128 v[68:71], v8 offset:256
    v_exp_f32 v144, v144
    v_cvt_pk_bf16_f32 v129, v57, v129
    v_rcp_f32 v57, v121
    v_exp_f32 v145, v145
    v_mfma_f32_32x32x16_bf16 v[156:171], v[72:75], v[232:235], v[156:171]
    s_setprio 3
    s_waitcnt lgkmcnt(1)
    ds_read_b128 v[72:75], v9 offset:256
    v_cvt_pk_bf16_f32 v130, v58, v130
    v_rcp_f32 v58, v122
    v_exp_f32 v146, v146
    v_cvt_pk_bf16_f32 v131, v59, v131
    v_rcp_f32 v59, v123
    v_exp_f32 v147, v147
    v_pk_mul_f32 v[132:133], v[132:133], v[52:53]
    v_pk_mul_f32 v[134:135], v[134:135], v[54:55]
    v_pk_mul_f32 v[136:137], v[136:137], v[56:57]
    v_pk_mul_f32 v[138:139], v[138:139], v[58:59]
    v_pk_add_f32 v[140:141], v[140:141], 1.0 op_sel_hi:[1,0]
    v_pk_add_f32 v[142:143], v[142:143], 1.0 op_sel_hi:[1,0]
    v_pk_add_f32 v[144:145], v[144:145], 1.0 op_sel_hi:[1,0]
    v_pk_add_f32 v[146:147], v[146:147], 1.0 op_sel_hi:[1,0]
    s_cbranch_scc1 TAIL
    v_mfma_f32_32x32x16_bf16 v[108:123], v[60:63], v[172:175], 0
    s_setprio 1
    ds_read_b64_tr_b16 v[46:47], v17 offset:0
    v_cvt_pk_bf16_f32 v132, v52, v132
    v_rcp_f32 v52, v140
    v_exp_f32 v148, v148
    v_cvt_pk_bf16_f32 v133, v53, v133
    v_mfma_f32_32x32x16_bf16 v[108:123], v[64:67], v[176:179], v[108:123]
    s_waitcnt lgkmcnt(1)
    ds_read_b64_tr_b16 v[48:49], v18 offset:0
    v_rcp_f32 v53, v141
    v_exp_f32 v149, v149
    v_cvt_pk_bf16_f32 v134, v54, v134
    v_rcp_f32 v54, v142
    v_exp_f32 v150, v150
    v_mfma_f32_32x32x16_bf16 v[108:123], v[68:71], v[180:183], v[108:123]
    s_add_u32 m0, s67, 0
    ds_read_b64_tr_b16 v[50:51], v19 offset:0
    v_cvt_pk_bf16_f32 v135, v55, v135
    v_rcp_f32 v55, v143
    v_exp_f32 v151, v151
    v_cvt_pk_bf16_f32 v136, v56, v136
    v_mfma_f32_32x32x16_bf16 v[108:123], v[72:75], v[184:187], v[108:123]
    s_or_b32 s3, s66, s90
    buffer_load_dwordx4 v[20:21], s[32:35], s84 idxen offen offset:0 lds
    v_rcp_f32 v56, v144
    v_exp_f32 v152, v152
    v_cvt_pk_bf16_f32 v137, v57, v137
    v_rcp_f32 v57, v145
    v_exp_f32 v153, v153
    v_smfmac_f32_32x32x32_bf16 v[108:123], v[28:31], v[236:243], v10 abid:1
    s_setprio 3
    s_waitcnt lgkmcnt(0)
    buffer_load_dwordx4 v[22:23], s[32:35], s85 idxen offen offset:1024 lds
    v_cvt_pk_bf16_f32 v138, v58, v138
    v_rcp_f32 v58, v146
    v_exp_f32 v154, v154
    v_cvt_pk_bf16_f32 v139, v59, v139
    v_rcp_f32 v59, v147
    v_exp_f32 v155, v155
    v_lshl_add_u64 v[2:3], v[2:3], 0, s[80:81]
    v_lshl_add_u64 v[4:5], v[4:5], 0, s[80:81]
    v_lshl_add_u64 v[6:7], v[6:7], 0, s[82:83]
    v_pk_mul_f32 v[156:157], v[156:157], v[52:53]
    v_pk_mul_f32 v[158:159], v[158:159], v[54:55]
    v_pk_mul_f32 v[160:161], v[160:161], v[56:57]
    v_pk_mul_f32 v[162:163], v[162:163], v[58:59]
    v_pk_add_f32 v[148:149], v[148:149], 1.0 op_sel_hi:[1,0]
    v_pk_add_f32 v[150:151], v[150:151], 1.0 op_sel_hi:[1,0]
    v_pk_add_f32 v[152:153], v[152:153], 1.0 op_sel_hi:[1,0]
    v_pk_add_f32 v[154:155], v[154:155], 1.0 op_sel_hi:[1,0]
    s_cbranch_scc1 LOOP
    s_branch HALF0
HALF1:
    v_add_u32 v3, 512, v3
HALF0:
    s_setprio 1
    ds_read_u8 v16, v3 offset:12
    ds_read_u8 v17, v3 offset:76
    v_smfmac_f32_32x32x32_bf16 v[76:91], v[44:47], v[124:131], v1
    v_cvt_pk_bf16_f32 v156, v52, v156
    v_rcp_f32 v52, v148
    v_exp_f32 v108, v108
    v_smfmac_f32_32x32x32_bf16 v[76:91], v[48:51], v[132:139], v1
    v_cvt_pk_bf16_f32 v157, v53, v157
    v_rcp_f32 v53, v149
    v_exp_f32 v109, v109
    v_mfma_f32_32x32x16_bf16 v[124:139], v[60:63], v[204:207], 0
    v_cvt_pk_bf16_f32 v158, v54, v158
    v_rcp_f32 v54, v150
    v_exp_f32 v110, v110
    v_cvt_pk_bf16_f32 v159, v55, v159
    v_mfma_f32_32x32x16_bf16 v[124:139], v[64:67], v[208:211], v[124:139]
    v_rcp_f32 v55, v151
    v_exp_f32 v111, v111
    v_cvt_pk_bf16_f32 v160, v56, v160
    v_rcp_f32 v56, v152
    v_mfma_f32_32x32x16_bf16 v[124:139], v[68:71], v[212:215], v[124:139]
    v_exp_f32 v112, v112
    v_cvt_pk_bf16_f32 v161, v57, v161
    v_rcp_f32 v57, v153
    v_exp_f32 v113, v113
    v_mfma_f32_32x32x16_bf16 v[124:139], v[72:75], v[216:219], v[124:139]
    v_cvt_pk_bf16_f32 v162, v58, v162
    v_rcp_f32 v58, v154
    v_exp_f32 v114, v114
    v_cvt_pk_bf16_f32 v163, v59, v163
    v_rcp_f32 v59, v155
    v_exp_f32 v115, v115
    s_setprio 3
    v_pk_mul_f32 v[164:165], v[164:165], v[52:53]
    v_pk_mul_f32 v[166:167], v[166:167], v[54:55]
    v_pk_mul_f32 v[168:169], v[168:169], v[56:57]
    v_pk_mul_f32 v[170:171], v[170:171], v[58:59]
    v_pk_add_f32 v[108:109], v[108:109], 1.0 op_sel_hi:[1,0]
    v_pk_add_f32 v[110:111], v[110:111], 1.0 op_sel_hi:[1,0]
    v_pk_add_f32 v[112:113], v[112:113], 1.0 op_sel_hi:[1,0]
    v_pk_add_f32 v[114:115], v[114:115], 1.0 op_sel_hi:[1,0]
    s_setprio 1
    v_mfma_f32_32x32x16_bf16 v[140:155], v[60:63], v[188:191], 0
    v_cvt_pk_bf16_f32 v164, v52, v164
    v_rcp_f32 v52, v108
    v_cvt_pk_bf16_f32 v165, v53, v165
    v_mfma_f32_32x32x16_bf16 v[140:155], v[64:67], v[192:195], v[140:155]
    v_rcp_f32 v53, v109
    v_cvt_pk_bf16_f32 v166, v54, v166
    v_rcp_f32 v54, v110
    v_mfma_f32_32x32x16_bf16 v[140:155], v[68:71], v[196:199], v[140:155]
    v_cvt_pk_bf16_f32 v167, v55, v167
    v_rcp_f32 v55, v111
    v_cvt_pk_bf16_f32 v168, v56, v168
    v_mfma_f32_32x32x16_bf16 v[140:155], v[72:75], v[200:203], v[140:155]
    v_rcp_f32 v56, v112
    v_cvt_pk_bf16_f32 v169, v57, v169
    v_rcp_f32 v57, v113
    v_smfmac_f32_32x32x32_bf16 v[140:155], v[28:31], v[244:251], v10 abid:1
    v_cvt_pk_bf16_f32 v170, v58, v170
    v_rcp_f32 v58, v114
    v_cvt_pk_bf16_f32 v171, v59, v171
    v_rcp_f32 v59, v115
    v_mul_f32 v124, v52, v124
    v_mul_f32 v125, v53, v125
    v_mul_f32 v126, v54, v126
    v_mul_f32 v127, v55, v127
    v_mul_f32 v128, v56, v128
    v_mul_f32 v129, v57, v129
    v_mul_f32 v130, v58, v130
    v_mul_f32 v131, v59, v131
    v_smfmac_f32_32x32x32_bf16 v[92:107], v[44:47], v[156:163], v1
    s_waitcnt lgkmcnt(0)
    ds_read_b64_tr_b16 v[44:45], v16 offset:0
    ds_read_b64_tr_b16 v[46:47], v17 offset:0
    v_cvt_pk_bf16_f32 v124, v52, v124
    v_smfmac_f32_32x32x32_bf16 v[92:107], v[48:51], v[164:171], v1
    v_exp_f32 v140, v140
    v_cvt_pk_bf16_f32 v125, v53, v125
    v_exp_f32 v141, v141
    v_mfma_f32_32x32x16_bf16 v[156:171], v[60:63], v[220:223], 0
    v_cvt_pk_bf16_f32 v126, v54, v126
    v_exp_f32 v142, v142
    v_cvt_pk_bf16_f32 v127, v55, v127
    v_mfma_f32_32x32x16_bf16 v[156:171], v[64:67], v[224:227], v[156:171]
    v_exp_f32 v143, v143
    v_cvt_pk_bf16_f32 v128, v56, v128
    v_exp_f32 v144, v144
    v_mfma_f32_32x32x16_bf16 v[156:171], v[68:71], v[228:231], v[156:171]
    v_cvt_pk_bf16_f32 v129, v57, v129
    v_exp_f32 v145, v145
    v_cvt_pk_bf16_f32 v130, v58, v130
    v_mfma_f32_32x32x16_bf16 v[156:171], v[72:75], v[232:235], v[156:171]
    v_exp_f32 v146, v146
    v_cvt_pk_bf16_f32 v131, v59, v131
    v_exp_f32 v147, v147
    v_add_f32 v140, 1.0, v140
    v_add_f32 v141, 1.0, v141
    v_add_f32 v142, 1.0, v142
    v_add_f32 v143, 1.0, v143
    v_add_f32 v144, 1.0, v144
    v_add_f32 v145, 1.0, v145
    v_add_f32 v146, 1.0, v146
    v_add_f32 v147, 1.0, v147
    s_waitcnt lgkmcnt(0)
    v_smfmac_f32_32x32x32_bf16 v[76:91], v[44:47], v[124:131], v1
    v_rcp_f32 v52, v140
    v_rcp_f32 v53, v141
    v_rcp_f32 v54, v142
    v_rcp_f32 v55, v143
    v_rcp_f32 v56, v144
    v_rcp_f32 v57, v145
    v_rcp_f32 v58, v146
    v_rcp_f32 v59, v147
    v_lshrrev_b32 v11, 5, v0
    v_mul_f32 v156, v52, v156
    v_mul_f32 v157, v53, v157
    v_mul_f32 v158, v54, v158
    v_mul_f32 v159, v55, v159
    v_mul_f32 v160, v56, v160
    v_mul_f32 v161, v57, v161
    v_mul_f32 v162, v58, v162
    v_mul_f32 v163, v59, v163
    v_cvt_pk_bf16_f32 v156, v52, v156
    v_cvt_pk_bf16_f32 v157, v53, v157
    v_cvt_pk_bf16_f32 v158, v54, v158
    v_cvt_pk_bf16_f32 v159, v55, v159
    v_cvt_pk_bf16_f32 v160, v56, v160
    v_cvt_pk_bf16_f32 v161, v57, v161
    v_cvt_pk_bf16_f32 v162, v58, v162
    v_cvt_pk_bf16_f32 v163, v59, v163
    v_and_b32 v12, 31, v0
    v_lshlrev_b32 v12, 2, v12
    v_mul_u32_u24 v13, 0x240, v11
    v_xor_b32 v13, v13, v12
    v_add_u32 v13, s73, v13
    v_smfmac_f32_32x32x32_bf16 v[92:107], v[44:47], v[156:163], v1
    s_branch FIN
TAIL:
    s_setprio 2
    ds_read_b64_tr_b16 v[46:47], v17 offset:0
    ds_read_b64_tr_b16 v[48:49], v18 offset:0
    ds_read_b64_tr_b16 v[50:51], v19 offset:0
    v_cvt_pk_bf16_f32 v132, v52, v132
    v_rcp_f32 v52, v140
    v_exp_f32 v148, v148
    v_cvt_pk_bf16_f32 v133, v53, v133
    v_rcp_f32 v53, v141
    v_exp_f32 v149, v149
    v_cvt_pk_bf16_f32 v134, v54, v134
    v_rcp_f32 v54, v142
    v_exp_f32 v150, v150
    v_cvt_pk_bf16_f32 v135, v55, v135
    v_rcp_f32 v55, v143
    v_exp_f32 v151, v151
    v_cvt_pk_bf16_f32 v136, v56, v136
    v_rcp_f32 v56, v144
    v_exp_f32 v152, v152
    v_cvt_pk_bf16_f32 v137, v57, v137
    v_rcp_f32 v57, v145
    v_exp_f32 v153, v153
    v_cvt_pk_bf16_f32 v138, v58, v138
    v_rcp_f32 v58, v146
    v_exp_f32 v154, v154
    v_cvt_pk_bf16_f32 v139, v59, v139
    v_rcp_f32 v59, v147
    v_exp_f32 v155, v155
    s_waitcnt lgkmcnt(0)
    v_smfmac_f32_32x32x32_bf16 v[76:91], v[44:47], v[124:131], v1
    v_mul_f32 v156, v52, v156
    v_mul_f32 v157, v53, v157
    v_mul_f32 v158, v54, v158
    v_mul_f32 v159, v55, v159
    v_mul_f32 v160, v56, v160
    v_mul_f32 v161, v57, v161
    v_mul_f32 v162, v58, v162
    v_mul_f32 v163, v59, v163
    v_smfmac_f32_32x32x32_bf16 v[76:91], v[48:51], v[132:139], v1
    v_add_f32 v148, 1.0, v148
    v_add_f32 v149, 1.0, v149
    v_add_f32 v150, 1.0, v150
    v_add_f32 v151, 1.0, v151
    v_add_f32 v152, 1.0, v152
    v_add_f32 v153, 1.0, v153
    v_add_f32 v154, 1.0, v154
    v_add_f32 v155, 1.0, v155
    v_cvt_pk_bf16_f32 v156, v52, v156
    v_rcp_f32 v52, v148
    v_cvt_pk_bf16_f32 v157, v53, v157
    v_rcp_f32 v53, v149
    v_cvt_pk_bf16_f32 v158, v54, v158
    v_rcp_f32 v54, v150
    v_cvt_pk_bf16_f32 v159, v55, v159
    v_rcp_f32 v55, v151
    v_cvt_pk_bf16_f32 v160, v56, v160
    v_rcp_f32 v56, v152
    v_cvt_pk_bf16_f32 v161, v57, v161
    v_rcp_f32 v57, v153
    v_cvt_pk_bf16_f32 v162, v58, v162
    v_rcp_f32 v58, v154
    v_cvt_pk_bf16_f32 v163, v59, v163
    v_rcp_f32 v59, v155
    v_lshrrev_b32 v11, 5, v0
    v_and_b32 v12, 31, v0
    v_smfmac_f32_32x32x32_bf16 v[92:107], v[44:47], v[156:163], v1
    v_mul_f32 v164, v52, v164
    v_mul_f32 v165, v53, v165
    v_mul_f32 v166, v54, v166
    v_mul_f32 v167, v55, v167
    v_mul_f32 v168, v56, v168
    v_mul_f32 v169, v57, v169
    v_mul_f32 v170, v58, v170
    v_mul_f32 v171, v59, v171
    v_cvt_pk_bf16_f32 v164, v52, v164
    v_cvt_pk_bf16_f32 v165, v53, v165
    v_cvt_pk_bf16_f32 v166, v54, v166
    v_cvt_pk_bf16_f32 v167, v55, v167
    v_cvt_pk_bf16_f32 v168, v56, v168
    v_cvt_pk_bf16_f32 v169, v57, v169
    v_cvt_pk_bf16_f32 v170, v58, v170
    v_cvt_pk_bf16_f32 v171, v59, v171
    v_lshlrev_b32 v12, 2, v12
    v_mul_u32_u24 v13, 0x240, v11
    v_xor_b32 v13, v13, v12
    v_add_u32 v13, s73, v13
    v_smfmac_f32_32x32x32_bf16 v[92:107], v[48:51], v[164:171], v1
FIN:
    s_setprio 3
    s_add_u32 s65, s65, 512
    s_cmp_lt_u32 s65, s64
    s_cbranch_scc1 MORE
    v_xor_b32 v69, 16, v13
    v_xor_b32 v70, 32, v13
    v_xor_b32 v71, 48, v13
    ds_read_b32 v60, v13 offset:0
    ds_read_b32 v64, v13 offset:1024
    ds_read_b32 v61, v69 offset:128
    ds_read_b32 v65, v69 offset:1152
    ds_read_b32 v62, v70 offset:256
    ds_read_b32 v66, v70 offset:1280
    ds_read_b32 v63, v71 offset:384
    v_lshlrev_b32 v108, 16, v36
    v_and_b32 v116, 0xffff0000, v36
    v_lshlrev_b32 v109, 16, v37
    v_and_b32 v117, 0xffff0000, v37
    v_lshlrev_b32 v110, 16, v38
    v_and_b32 v118, 0xffff0000, v38
    v_lshlrev_b32 v111, 16, v39
    v_and_b32 v119, 0xffff0000, v39
    v_lshlrev_b32 v112, 16, v40
    v_and_b32 v120, 0xffff0000, v40
    v_lshlrev_b32 v113, 16, v41
    v_and_b32 v121, 0xffff0000, v41
    v_lshlrev_b32 v114, 16, v42
    v_and_b32 v122, 0xffff0000, v42
    v_lshl_add_u32 v72, v11, 9, v12
    s_movk_i32 s3, 384
    v_mad_u32_u24 v73, v11, s3, v12
    v_rcp_f32 v76, v76
    v_rcp_f32 v77, v77
    v_rcp_f32 v78, v78
    v_rcp_f32 v79, v79
    v_rcp_f32 v80, v80
    v_rcp_f32 v81, v81
    v_rcp_f32 v82, v82
    v_rcp_f32 v92, v92
    v_rcp_f32 v93, v93
    v_rcp_f32 v94, v94
    v_rcp_f32 v95, v95
    v_rcp_f32 v96, v96
    v_rcp_f32 v97, v97
    v_rcp_f32 v98, v98
    s_waitcnt lgkmcnt(0)
    v_lshlrev_b32 v124, 16, v60
    v_and_b32 v132, 0xffff0000, v60
    v_lshlrev_b32 v125, 16, v61
    v_and_b32 v133, 0xffff0000, v61
    v_lshlrev_b32 v126, 16, v62
    v_and_b32 v134, 0xffff0000, v62
    v_lshlrev_b32 v127, 16, v63
    v_and_b32 v135, 0xffff0000, v63
    v_lshlrev_b32 v128, 16, v64
    v_and_b32 v136, 0xffff0000, v64
    v_lshlrev_b32 v129, 16, v65
    v_and_b32 v137, 0xffff0000, v65
    v_lshlrev_b32 v130, 16, v66
    v_and_b32 v138, 0xffff0000, v66
    v_pk_fma_f32 v[108:109], v[76:77], v[84:85], v[108:109]
    v_pk_fma_f32 v[110:111], v[78:79], v[86:87], v[110:111]
    v_pk_fma_f32 v[112:113], v[80:81], v[88:89], v[112:113]
    v_pk_fma_f32 v[114:115], v[82:83], v[90:91], v[114:115]
    v_pk_fma_f32 v[116:117], v[92:93], v[100:101], v[116:117]
    v_pk_fma_f32 v[118:119], v[94:95], v[102:103], v[118:119]
    v_pk_fma_f32 v[120:121], v[96:97], v[104:105], v[120:121]
    v_pk_fma_f32 v[122:123], v[98:99], v[106:107], v[122:123]
    v_max_f32 v108, 0, v108
    v_max_f32 v109, 0, v109
    v_max_f32 v110, 0, v110
    v_max_f32 v111, 0, v111
    v_max_f32 v112, 0, v112
    v_max_f32 v113, 0, v113
    v_max_f32 v114, 0, v114
    v_max_f32 v116, 0, v116
    v_max_f32 v117, 0, v117
    v_max_f32 v118, 0, v118
    v_max_f32 v119, 0, v119
    v_max_f32 v120, 0, v120
    v_max_f32 v121, 0, v121
    v_max_f32 v122, 0, v122
    v_pk_add_f32 v[108:109], v[108:109], v[124:125]
    v_pk_add_f32 v[116:117], v[116:117], v[132:133]
    v_pk_add_f32 v[110:111], v[110:111], v[126:127]
    v_pk_add_f32 v[118:119], v[118:119], v[134:135]
    v_pk_add_f32 v[112:113], v[112:113], v[128:129]
    v_pk_add_f32 v[120:121], v[120:121], v[136:137]
    v_pk_add_f32 v[114:115], v[114:115], v[130:131]
    v_pk_add_f32 v[122:123], v[122:123], v[138:139]
    v_cvt_pk_bf16_f32 v36, v108, v116
    buffer_store_dword v36, v72, s[44:47], 0 offen offset:0 sc1
    v_cvt_pk_bf16_f32 v37, v109, v117
    buffer_store_dword v37, v72, s[44:47], 0 offen offset:128 sc1
    v_cvt_pk_bf16_f32 v38, v110, v118
    buffer_store_dword v38, v72, s[44:47], 0 offen offset:256 sc1
    v_cvt_pk_bf16_f32 v39, v111, v119
    buffer_store_dword v39, v72, s[44:47], 0 offen offset:384 sc1
    v_cvt_pk_bf16_f32 v40, v112, v120
    buffer_store_dword v40, v73, s[44:47], 0 offen offset:1024 sc1
    v_cvt_pk_bf16_f32 v41, v113, v121
    buffer_store_dword v41, v73, s[44:47], 0 offen offset:1152 sc1
    v_cvt_pk_bf16_f32 v42, v114, v122
    buffer_store_dword v42, v73, s[44:47], 0 offen offset:1280 sc1
K_END:
    s_endpgm
FX0_R:
    s_mov_b64 exec, vcc
    buffer_load_dwordx4 v[32:35], v14, s[40:43], 0 idxen sc0 sc1
    s_mov_b64 exec, -1
    s_sub_u32 s76, s76, 1
    s_waitcnt vmcnt(0)
    s_cbranch_scc0 FX0
    s_endpgm
FX1_R:
    s_mov_b64 exec, vcc
    buffer_load_dwordx4 v[44:47], v10, s[40:43], 0 idxen sc0 sc1
    s_mov_b64 exec, -1
    s_sub_u32 s76, s76, 1
    s_waitcnt vmcnt(0)
    s_cbranch_scc0 FX1
    s_endpgm
FXP_R:
    s_mov_b64 exec, vcc
    buffer_load_dwordx4 v[32:35], v14, s[40:43], 0 idxen sc0 sc1
    s_mov_b64 exec, -1
    s_sub_u32 s76, s76, 1
    s_waitcnt vmcnt(0)
    s_cbranch_scc0 FXP
    s_endpgm
FXL_R:
    s_mov_b64 exec, vcc
    buffer_load_dwordx4 v[32:35], v14, s[40:43], 0 idxen sc0 sc1
    s_mov_b64 exec, -1
    s_sub_u32 s76, s76, 1
    s_waitcnt vmcnt(0)
    s_cbranch_scc0 FXL
    s_endpgm
PUB_X:
    v_lshl_or_b32 v140, v137, 16, v136
    v_lshl_or_b32 v141, v139, 16, v138
    v_or_b32 v142, s75, v145
    v_mov_b32 v143, s74
    s_lshl_b32 s3, s2, 13
    s_add_u32 s3, s3, 524288
    buffer_store_dwordx4 v[140:143], v61, s[36:39], s3 offen sc1
    s_branch PUB_C
ESCAPE:
    s_mov_b64 s[4:5], vcc
    v_lshlrev_b32 v144, 2, v144
    s_lshl_b32 s97, s70, 5
    s_add_u32 s97, s97, 524288
ESC_L:
    s_mov_b64 exec, vcc
    buffer_load_dwordx4 v[80:83], v144, s[36:39], s97 offen sc0 sc1
    buffer_load_dwordx4 v[84:87], v144, s[36:39], s97 offen offset:16 sc0 sc1
    s_waitcnt vmcnt(0)
    v_xor_b32 v11, s75, v82
    v_xor_b32 v12, s75, v86
    v_or_b32 v11, v11, v12
    v_lshrrev_b32 v11, 16, v11
    v_xor_b32 v12, s74, v83
    v_xor_b32 v147, s74, v87
    v_or3_b32 v11, v11, v12, v147
    v_cmp_ne_u32 vcc, 0, v11
    s_cmp_eq_u64 vcc, 0
    s_cbranch_scc1 ESC_OK
    s_sub_u32 s76, s76, 1
    s_cbranch_scc0 ESC_L
    s_endpgm
ESC_OK:
    s_mov_b64 exec, s[4:5]
    v_mov_b32 v68, v80
    v_alignbit_b32 v69, v81, v80, 16
    v_mov_b32 v70, v81
    v_alignbit_b32 v71, v82, v81, 16
    v_mov_b32 v72, v84
    v_alignbit_b32 v73, v85, v84, 16
    v_mov_b32 v74, v85
    v_alignbit_b32 v75, v86, v85, 16
    s_mov_b64 exec, -1
    s_branch ESC_DONE
LATER:
    ds_read_b32 v14, v6 offset:6128
    ds_read_b32 v10, v6 offset:6384
    v_bfe_u32 v11, v0, 2, 2
    v_lshrrev_b32 v12, 5, v0
    v_lshl_or_b32 v11, v12, 3, v11
    v_lshl_add_u32 v2, v11, 4, s68
    v_and_b32 v11, 3, v0
    v_add_u32 v3, v11, v2
    v_and_b32 v11, 31, v0
    v_lshl_add_u32 v4, v11, 4, s68
    v_lshl_add_u32 v5, v12, 2, v4
    v_lshl_add_u32 v7, v0, 4, s68
    s_min_u32 s64, s64, s77
    s_sub_u32 s3, s64, s65
    s_min_u32 s3, s3, 512
    s_add_u32 s3, s3, 31
    s_bitcmp0_b32 s3, 4
    s_cselect_b32 s90, 0, -1
    s_lshr_b32 s3, s3, 5
    s_max_u32 s3, s3, 1
    s_sub_u32 s66, s3, 1
    s_mov_b32 s72, 2
    s_waitcnt lgkmcnt(0)
    buffer_load_dwordx4 v[32:35], v14, s[40:43], 0 idxen
    buffer_load_dwordx4 v[44:47], v10, s[40:43], 0 idxen
    s_branch NOW
MORE:
    s_mov_b32 s77, 800000
    s_mov_b32 s69, 0
    s_waitcnt vmcnt(0) lgkmcnt(0)
    s_nop 15
    s_and_b32 s3, s61, 7
    s_lshl_b32 s3, s3, 10
    s_add_u32 s3, s3, 148480
    v_lshl_add_u32 v11, v0, 4, s3
    ds_read_b128 v[140:143], v11
    v_mov_b32 v156, 0
    v_mov_b32 v157, 0
    v_mov_b32 v158, 0
    v_mov_b32 v159, 0
    v_lshl_add_u32 v168, v0, 5, s68
    v_mul_u32_u24 v169, 12800, v0
    v_subrev_u32 v169, s65, v169
    v_lshl_add_u32 v171, v0, 3, s65
    v_mov_b32 v4, 512
    v_mov_b32 v170, 0
    v_lshl_add_u32 v6, v0, 2, s68
    s_lshl_b32 s3, s60, 2
    v_mov_b32 v5, s3
    ds_write_b128 v168, v[156:159] offset:6128
    ds_write_b128 v168, v[156:159] offset:6144
    s_waitcnt lgkmcnt(0)
    s_branch EXPAND
.section .rodata,"a"
.p2align 6
.amdhsa_kernel standalone__edge_featured_mpnn_gatedgcn__graph_kernel
  .amdhsa_next_free_vgpr 256
  .amdhsa_next_free_sgpr 102
  .amdhsa_accum_offset 256
  .amdhsa_group_segment_fixed_size 0
  .amdhsa_kernarg_size 96
  .amdhsa_user_sgpr_count 2
  .amdhsa_user_sgpr_kernarg_segment_ptr 1
  .amdhsa_system_sgpr_workgroup_id_x 1
.end_amdhsa_kernel
```
